```python
import torch

def _softmax(x, axis=-1):
    return torch.softmax(x, dim=axis)
def _gelu(x):
    return torch.nn.functional.gelu(x, approximate="tanh")
def _silu(x):
    return torch.nn.functional.silu(x)
def _sigmoid(x):
    return torch.sigmoid(x)
def _layernorm(x, axis=-1, eps=1e-5):
    m = x.mean(dim=axis, keepdim=True)
    v = x.var(dim=axis, keepdim=True, unbiased=False)
    return (x - m) / torch.sqrt(v + eps)
def _scatter_add(tgt, idx, src, axis=0):
    return tgt.clone().index_add_(axis, idx, src)
def _segment_sum(src, seg, n):
    out = torch.zeros((n,) + src.shape[1:], dtype=src.dtype)
    return out.index_add_(0, seg, src)
def _pad(x, pw):
    flat = tuple(v for pair in reversed(pw) for v in pair)
    return torch.nn.functional.pad(x, flat)

kernel_name = 'gated_mix__ssm_conv_h3__glu_gated_glu__prompt'

def setup_inputs():

    _w = (lambda a: (lambda t: t.to(torch.bfloat16) if t.is_floating_point() else t)(torch.as_tensor(a)))
    def _A_setup():
        B, S, D = 1, 2048, 640
        ks = 4
        return {
            "q": _w((lambda *s: torch.randn(*s, dtype=torch.bfloat16) * 0.05)(B, S, D)),
            "k": _w((lambda *s: torch.randn(*s, dtype=torch.bfloat16) * 0.4)(B, S, D)),
            "v": _w((lambda *s: torch.randn(*s, dtype=torch.bfloat16) * 0.4)(B, S, D)),
            "shift_k": _w((lambda *s: torch.randn(*s, dtype=torch.bfloat16) * 0.4)(D, ks) * 0.5),
            "ssm_k": _w((lambda *s: torch.randn(*s, dtype=torch.bfloat16) * 1.6)(D, S) * (1.0 / S ** 0.5)),
            "ssm_D": _w((lambda *s: torch.randn(*s, dtype=torch.bfloat16) * 0.4)(D)),
        }
    _A_in = _A_setup()

    def _B_setup():
        B, S, D, F = 1, 2048, 640, 1536
        return {
            "x": _w((lambda *s: torch.randn(*s, dtype=torch.bfloat16) * 0.05)(B, S, D)),
            "w_gate": _w((lambda *s: torch.randn(*s, dtype=torch.bfloat16) * 0.4)(D, F)),
            "w_up": _w((lambda *s: torch.randn(*s, dtype=torch.bfloat16) * 0.05)(D, F)),
            "w_down": _w((lambda *s: torch.randn(*s, dtype=torch.bfloat16) * 0.05)(F, D)),
        }
    _B_in = _B_setup()

    return {
        "A_q": _A_in["q"],
        "A_k": _A_in["k"],
        "A_v": _A_in["v"],
        "A_shift_k": _A_in["shift_k"],
        "A_ssm_k": _A_in["ssm_k"],
        "A_ssm_D": _A_in["ssm_D"],
        "B_x": _B_in["x"],
        "B_w_gate": _B_in["w_gate"],
        "B_w_up": _B_in["w_up"],
        "B_w_down": _B_in["w_down"],
        "gate_w": _w((lambda *s: torch.randn(*s, dtype=torch.bfloat16) * 0.05)(640) * 16.0),
    }

def reference(A_q, A_k, A_v, A_shift_k, A_ssm_k, A_ssm_D, B_x, B_w_gate, B_w_up, B_w_down, gate_w):
    def _A_ref(q, k, v, shift_k, ssm_k, ssm_D):
        B, S, D = q.shape
        ks = shift_k.shape[-1]
        k_pad = _pad(k, ((0, 0), (ks - 1, 0), (0, 0)))
        k_shift = torch.zeros_like(k)
        for t in range(ks):
            k_shift = k_shift + k_pad[:, t:t + S, :] * shift_k[:, ks - 1 - t][None, None, :]
        kv = k_shift * v
        L = 2 * S
        kv_pad = _pad(kv, ((0, 0), (0, S), (0, 0)))
        kf_pad = _pad(ssm_k, ((0, 0), (0, S)))
        kv_f = (lambda x, axes=(-2,-1): torch.fft.rfft2(x.float(), dim=axes))(kv_pad[:, None, :, :], axes=(1, 2))
        kf_f = (lambda x, axes=(-2,-1): torch.fft.rfft2(x.float(), dim=axes))(kf_pad[:, None, :], axes=(1, 2))
        kf_f = (lambda x, *d: x.permute(*d))(kf_f, 1, 2, 0)
        y_f = kv_f * kf_f[None, :, :, :]
        y = (lambda x, s, axes=(-2,-1): torch.fft.irfft2(x, s=s, dim=axes).to(torch.bfloat16))(y_f, (1, L), axes=(1, 2))[:, 0, :S, :]
        y = y + kv * ssm_D[None, None, :]
        return q * y

    def _B_ref(x, w_gate, w_up, w_down):
        g = torch.einsum("bsd,df->bsf", x, w_gate)
        u = torch.einsum("bsd,df->bsf", x, w_up)
        h = _sigmoid(g) * u
        return torch.einsum("bsf,fd->bsd", h, w_down)

    x = A_q
    g = _sigmoid((x * gate_w).sum(-1, keepdims=True))
    a = _A_ref(x, A_k, A_v, A_shift_k, A_ssm_k, A_ssm_D)
    b = _B_ref(x, B_w_gate, B_w_up, B_w_down)
    return g * a + (1 - g) * b
```

```asm
; @launch grid=(256,1,1) block=(512,1,1) lds=163840
.amdgcn_target "amdgcn-amd-amdhsa--gfx950"
.text
.globl gated_mix__ssm_conv_h3__glu_gated_glu__prompt_kernel
.p2align 8
.type gated_mix__ssm_conv_h3__glu_gated_glu__prompt_kernel,@function
gated_mix__ssm_conv_h3__glu_gated_glu__prompt_kernel:
    s_cmp_ge_u32 s2, 256
    s_cbranch_scc1 L_end
    s_load_dwordx16 s[16:31], s[0:1], 0
    s_load_dwordx8 s[32:39], s[0:1], 64
    s_load_dwordx4 s[40:43], s[0:1], 96
    v_lshrrev_b32 v2, 6, v0
    v_and_b32 v1, 63, v0
    s_mov_b32 s101, 0xffff0000
    s_mov_b32 s100, 0
    s_getpc_b64 s[14:15]
L_pc:
    v_lshlrev_b32 v4, 7, v0
    v_min_u32 v4, L_code_end-L_pc-4, v4
    v_readfirstlane_b32 s3, v2
    v_cmp_gt_u32 vcc, (L_code_end-L_pc+127)/128, v0
    s_and_saveexec_b64 s[12:13], vcc
    s_cbranch_execz L_nopf
    global_load_dword v135, v4, s[14:15]
L_nopf:
    s_mov_b64 exec, -1
    v_mov_b32 v0, 161792
    s_and_b32 s4, s2, 7
    s_lshr_b32 s5, s2, 3
    s_and_b32 s11, s4, 1
    s_lshr_b32 s12, s4, 1
    s_and_b32 s13, s5, 7
    s_lshl3_add_u32 s6, s11, s13
    s_lshr_b32 s13, s5, 3
    s_lshl2_add_u32 s7, s12, s13
    s_and_b32 s13, s5, 3
    s_lshl2_add_u32 s9, s11, s13
    s_lshr_b32 s13, s5, 2
    s_lshl3_add_u32 s8, s12, s13
    s_lshr_b32 s13, s5, 3
    s_and_b32 s11, s13, 1
    s_lshl1_add_u32 s7, s12, s11
    s_lshr_b32 s13, s13, 1
    s_lshl3_add_u32 s7, s13, s7
    s_and_b32 s9, s5, 7
    s_lshr_b32 s13, s5, 3
    s_lshl2_add_u32 s8, s4, s13
    s_cmp_lt_u32 s3, 4
    s_cbranch_scc1 L_comp
    s_sub_u32 s68, s3, 4
    s_mov_b32 s11, 43691
    s_movk_i32 s12, 3072
    v_add_u32 v8, 0, v1
    v_mul_u32_u24 v9, s11, v8
    v_lshrrev_b32 v9, 19, v9
    v_mul_u32_u24 v10, 12, v9
    v_sub_u32 v8, v8, v10
    v_lshrrev_b32 v10, 2, v9
    v_and_b32 v10, 2, v10
    v_xor_b32 v8, v8, v10
    v_lshlrev_b32 v8, 4, v8
    v_mad_u32_u24 v4, v9, s12, v8
    v_add_u32 v8, 64, v1
    v_mul_u32_u24 v9, s11, v8
    v_lshrrev_b32 v9, 19, v9
    v_mul_u32_u24 v10, 12, v9
    v_sub_u32 v8, v8, v10
    v_lshrrev_b32 v10, 2, v9
    v_and_b32 v10, 2, v10
    v_xor_b32 v8, v8, v10
    v_lshlrev_b32 v8, 4, v8
    v_mad_u32_u24 v5, v9, s12, v8
    v_subrev_u32 v5, 1024, v5
    v_add_u32 v8, 128, v1
    v_mul_u32_u24 v9, s11, v8
    v_lshrrev_b32 v9, 19, v9
    v_mul_u32_u24 v10, 12, v9
    v_sub_u32 v8, v8, v10
    v_lshrrev_b32 v10, 2, v9
    v_and_b32 v10, 2, v10
    v_xor_b32 v8, v8, v10
    v_lshlrev_b32 v8, 4, v8
    v_mad_u32_u24 v6, v9, s12, v8
    v_subrev_u32 v6, 2048, v6
    v_lshrrev_b32 v8, 3, v1
    v_mul_u32_u24 v8, 1280, v8
    v_lshrrev_b32 v9, 4, v1
    v_xor_b32 v9, v9, v1
    v_and_b32 v9, 7, v9
    v_lshl_add_u32 v7, v9, 4, v8
    v_xor_b32 v9, 4, v9
    v_lshl_add_u32 v2, v9, 4, v8
    v_add_u32 v2, 9216, v2
    s_and_b32 s11, s68, 1
    s_lshr_b32 s12, s68, 1
    s_mul_i32 s69, s12, 6144
    s_mul_i32 s13, s11, 3072
    s_add_u32 s69, s69, s13
    s_lshl_b32 s70, s68, 12
    s_add_u32 s70, s70, 73728
    s_mul_i32 s71, s7, 192
    s_mul_i32 s13, s11, 49152
    s_add_u32 s71, s71, s13
    s_lshl2_add_u32 s13, s6, s68
    s_mul_i32 s72, s13, 40960
    s_add_u32 s73, s72, 18432
    s_lshr_b32 s11, s5, 3
    s_add_u32 s11, s11, s5
    s_and_b32 s11, s11, 3
    s_mul_i32 s96, s11, 5
    s_lshr_b32 s96, s96, 1
    s_add_u32 s96, s96, s4
    s_cmp_ge_u32 s96, 10
    s_cselect_b32 s11, 10, 0
    s_sub_u32 s96, s96, s11
    s_cmp_ge_u32 s96, 10
    s_cselect_b32 s11, 10, 0
    s_sub_u32 s96, s96, s11
    s_cmp_ge_u32 s96, 8
    s_cselect_b32 s11, 8, 0
    s_sub_u32 s96, s96, s11
    s_add_u32 s97, s96, 2
    s_mov_b32 s98, s97
    s_lshl_b32 s99, s97, 1
    s_waitcnt lgkmcnt(0)
    s_load_dword s10, s[42:43], 0
    s_cmp_lt_u32 s68, 2
    s_cselect_b64 s[52:53], s[30:31], s[32:33]
    s_mov_b32 s54, 1966080
    s_mov_b32 s55, 0x20000
    s_mov_b64 s[48:49], s[16:17]
    s_mov_b32 s50, 2621440
    s_mov_b32 s51, 0x20000
    s_add_u32 m0, s70, 0
    s_nop 0
    buffer_load_dwordx4 v7, s[48:51], s72 offen offset:0 lds
    buffer_load_dwordx4 v2, s[48:51], s72 offen offset:1024 lds
    s_add_u32 s72, s72, 128
    s_add_u32 m0, s70, 0
    s_nop 0
    buffer_load_dwordx4 v7, s[48:51], s73 offen offset:2048 lds
    buffer_load_dwordx4 v2, s[48:51], s73 offen offset:3072 lds
    s_add_u32 s73, s73, 128
    s_add_u32 m0, s69, 0
    s_nop 0
    buffer_load_dwordx4 v4, s[52:55], s71 offen offset:0 lds
    buffer_load_dwordx4 v5, s[52:55], s71 offen offset:1024 lds
    buffer_load_dwordx4 v6, s[52:55], s71 offen offset:2048 lds
    s_add_u32 s71, s71, 98304
    s_add_u32 m0, s69, 12288
    s_nop 0
    buffer_load_dwordx4 v4, s[52:55], s71 offen offset:0 lds
    buffer_load_dwordx4 v5, s[52:55], s71 offen offset:1024 lds
    buffer_load_dwordx4 v6, s[52:55], s71 offen offset:2048 lds
    s_add_u32 s71, s71, 98304
    s_add_u32 m0, s70, 16384
    s_nop 0
    buffer_load_dwordx4 v7, s[48:51], s72 offen offset:0 lds
    buffer_load_dwordx4 v2, s[48:51], s72 offen offset:1024 lds
    s_add_u32 s72, s72, 128
    s_lshl_b32 s11, s96, 7
    s_add_u32 s72, s72, s11
    s_mov_b64 s[44:45], s[42:43]
    s_mov_b32 s46, 16777216
    s_mov_b32 s47, 0x20000
    s_lshl_b32 s11, s9, 5
    s_add_u32 s11, s11, s8
    s_lshl_b32 s11, s11, 4
    s_lshl2_add_u32 s11, s68, s11
    s_add_u32 s78, s11, 4096
    s_cmp_eq_u32 s3, 7
    s_cbranch_scc1 L_svc
    s_cmp_lt_u32 s8, 16
    s_cselect_b32 s11, 3, 2
    s_cselect_b32 s12, 0, 16
    s_cmp_lt_u32 s68, s11
    s_cselect_b32 s77, 1, 0
    s_cselect_b32 s14, s68, 0
    s_mul_i32 s13, s8, s11
    s_add_u32 s13, s13, s12
    s_mul_i32 s74, s9, 80
    s_add_u32 s74, s74, s13
    s_add_u32 s74, s74, s14
    s_mul_i32 s75, s68, 12928
    s_add_u32 s75, s75, 122880
    s_lshl_b32 s11, s74, 1
    s_and_b32 s11, s11, 0xfffffffc
    s_load_dword s76, s[26:27], s11
    s_mov_b64 s[84:85], s[24:25]
    s_mov_b32 s86, 2621440
    s_mov_b32 s87, 0x20000
    v_and_b32 v10, 15, v1
    v_lshrrev_b32 v11, 4, v1
    v_and_b32 v12, 1, v1
    v_lshlrev_b32 v13, 1, v10
    v_lshl_add_u32 v13, v11, 4, v13
    v_cmp_eq_u32 vcc, 1, v12
    v_mov_b32 v8, 4160
    v_mov_b32 v9, 2
    v_cndmask_b32 v8, v8, v9, vcc
    v_add3_u32 v16, v13, v8, s75
    v_add_u32 v17, 1024, v16
    v_add_u32 v18, 2048, v16
    v_add_u32 v19, 3072, v16
    v_lshlrev_b32 v13, 5, v10
    v_lshlrev_b32 v8, 4, v11
    v_sub_u32 v8, v8, v13
    v_add_u32 v8, 8800, v8
    v_add_u32 v20, s75, v8
    v_lshlrev_b32 v8, 3, v11
    v_add_u32 v8, v8, v13
    v_add_u32 v22, s75, v8
    v_sub_u32 v21, 8824, v8
    v_add_u32 v21, s75, v21
    v_lshlrev_b32 v8, 4, v1
    v_add_u32 v9, 2, v8
    v_add_u32 v23, s75, v8
    s_waitcnt lgkmcnt(0)
    s_bitcmp1_b32 s74, 0
    s_cselect_b32 s12, 0, 16
    s_lshl_b32 s76, s76, s12
    s_and_b32 s76, s76, 0xffff0000
    v_mov_b32 v32, 0
    v_mov_b32 v33, 0
    v_mov_b32 v34, 0
    v_mov_b32 v35, 0
    v_mov_b32 v36, 0
    v_mov_b32 v37, 0
    v_mov_b32 v38, 0
    v_mov_b32 v39, 0
    v_mov_b32 v40, 0
    v_mov_b32 v41, 0
    v_mov_b32 v42, 0
    v_mov_b32 v43, 0
    v_mov_b32 v44, 0
    v_mov_b32 v45, 0
    v_mov_b32 v46, 0
    v_mov_b32 v47, 0
    v_mov_b32 v48, 0
    v_mov_b32 v49, 0
    v_mov_b32 v50, 0
    v_mov_b32 v51, 0
    v_mov_b32 v52, 0
    v_mov_b32 v53, 0
    v_mov_b32 v54, 0
    v_mov_b32 v55, 0
    v_mov_b32 v56, 0
    v_mov_b32 v57, 0
    v_mov_b32 v58, 0
    v_mov_b32 v59, 0
    v_mov_b32 v60, 0
    v_mov_b32 v61, 0
    v_mov_b32 v62, 0
    v_mov_b32 v63, 0
    s_setprio 2
    s_waitcnt lgkmcnt(0)
    s_mul_i32 s10, s10, 0x9E3779B1
    s_add_u32 s10, s10, 0x7F4A7C15
    s_waitcnt vmcnt(5)
    s_add_u32 m0, s70, 16384
    s_nop 0
    buffer_load_dwordx4 v7, s[48:51], s73 offen offset:2048 lds
    buffer_load_dwordx4 v2, s[48:51], s73 offen offset:3072 lds
    s_add_u32 s73, s73, 128
    s_lshl_b32 s11, s96, 7
    s_add_u32 s73, s73, s11
    s_add_u32 m0, s69, 24576
    s_nop 0
    buffer_load_dwordx4 v4, s[52:55], s71 offen offset:0 lds
    buffer_load_dwordx4 v5, s[52:55], s71 offen offset:1024 lds
    buffer_load_dwordx4 v6, s[52:55], s71 offen offset:2048 lds
    s_add_u32 s71, s71, 98304
    s_add_u32 m0, s69, 36864
    s_nop 0
    buffer_load_dwordx4 v4, s[52:55], s71 offen offset:0 lds
    buffer_load_dwordx4 v5, s[52:55], s71 offen offset:1024 lds
    buffer_load_dwordx4 v6, s[52:55], s71 offen offset:2048 lds
    s_add_u32 s71, s71, 98304
    s_mul_i32 s11, s96, 196608
    s_add_u32 s71, s71, s11
    s_add_u32 m0, s70, 32768
    s_nop 0
    buffer_load_dwordx4 v7, s[48:51], s72 offen offset:0 lds
    buffer_load_dwordx4 v2, s[48:51], s72 offen offset:1024 lds
    s_add_u32 s72, s72, 128
    s_add_u32 s97, s97, 1
    s_cmp_eq_u32 s97, 10
    s_cselect_b32 s11, 1024, 0
    s_sub_u32 s72, s72, s11
    s_add_u32 m0, s70, 32768
    s_nop 0
    buffer_load_dwordx4 v7, s[48:51], s73 offen offset:2048 lds
    buffer_load_dwordx4 v2, s[48:51], s73 offen offset:3072 lds
    s_add_u32 s73, s73, 128
    s_add_u32 s98, s98, 1
    s_cmp_eq_u32 s98, 10
    s_cselect_b32 s11, 1024, 0
    s_sub_u32 s73, s73, s11
    s_add_u32 m0, s69, 49152
    s_nop 0
    buffer_load_dwordx4 v4, s[52:55], s71 offen offset:0 lds
    buffer_load_dwordx4 v5, s[52:55], s71 offen offset:1024 lds
    buffer_load_dwordx4 v6, s[52:55], s71 offen offset:2048 lds
    s_add_u32 s71, s71, 98304
    s_add_u32 s99, s99, 1
    s_cmp_eq_u32 s99, 20
    s_cselect_b32 s11, 1572864, 0
    s_sub_u32 s71, s71, s11
    s_waitcnt lgkmcnt(0)
    s_barrier
    s_lshl_b32 s11, s68, 6
    v_add_u32 v69, s11, v1
    v_lshrrev_b32 v67, 3, v69
    v_and_b32 v68, 7, v69
    v_lshlrev_b32 v68, 4, v68
    v_mul_u32_u24 v64, 144, v67
    s_mov_b32 s12, 139264
    v_add3_u32 v64, v64, v68, s12
    v_lshl_add_u32 v65, v67, 12, v68
    s_mul_i32 s11, s9, 327680
    s_lshl_b32 s12, s8, 7
    s_sub_u32 s11, s11, s12
    s_add_u32 s11, s11, 1052544
    v_cmp_gt_u32 vcc, 64, v69
    v_mov_b32 v67, 2147483648
    ds_read_b128 v[72:75], v64 offset:0
    ds_read_b128 v[76:79], v64 offset:3456
    ds_read_b128 v[80:83], v64 offset:6912
    ds_read_b128 v[84:87], v64 offset:10368
    v_cndmask_b32 v66, v67, v65, vcc
    s_waitcnt lgkmcnt(3)
    buffer_store_dwordx4 v[72:75], v65, s[44:47], s11 offen sc1
    s_add_u32 s11, s11, 98304
    s_waitcnt lgkmcnt(2)
    buffer_store_dwordx4 v[76:79], v65, s[44:47], s11 offen sc1
    s_add_u32 s11, s11, 98304
    s_waitcnt lgkmcnt(1)
    buffer_store_dwordx4 v[80:83], v65, s[44:47], s11 offen sc1
    s_add_u32 s11, s11, 98304
    s_waitcnt lgkmcnt(0)
    buffer_store_dwordx4 v[84:87], v66, s[44:47], s11 offen sc1
    s_waitcnt vmcnt(21)
    s_barrier
    s_add_u32 m0, s69, 61440
    s_nop 0
    buffer_load_dwordx4 v4, s[52:55], s71 offen offset:0 lds
    buffer_load_dwordx4 v5, s[52:55], s71 offen offset:1024 lds
    buffer_load_dwordx4 v6, s[52:55], s71 offen offset:2048 lds
    s_add_u32 s71, s71, 98304
    s_add_u32 s99, s99, 1
    s_cmp_eq_u32 s99, 20
    s_cselect_b32 s11, 1572864, 0
    s_sub_u32 s71, s71, s11
    s_add_u32 m0, s70, 49152
    s_nop 0
    buffer_load_dwordx4 v7, s[48:51], s72 offen offset:0 lds
    buffer_load_dwordx4 v2, s[48:51], s72 offen offset:1024 lds
    s_add_u32 s72, s72, 128
    s_add_u32 s97, s97, 1
    s_cmp_eq_u32 s97, 10
    s_cselect_b32 s11, 1024, 0
    s_sub_u32 s72, s72, s11
    s_waitcnt vmcnt(19)
    s_barrier
    s_add_u32 m0, s70, 49152
    s_nop 0
    buffer_load_dwordx4 v7, s[48:51], s73 offen offset:2048 lds
    buffer_load_dwordx4 v2, s[48:51], s73 offen offset:3072 lds
    s_add_u32 s73, s73, 128
    s_add_u32 s98, s98, 1
    s_cmp_eq_u32 s98, 10
    s_cselect_b32 s11, 1024, 0
    s_sub_u32 s73, s73, s11
    s_add_u32 m0, s69, 0
    s_nop 0
    buffer_load_dwordx4 v4, s[52:55], s71 offen offset:0 lds
    buffer_load_dwordx4 v5, s[52:55], s71 offen offset:1024 lds
    buffer_load_dwordx4 v6, s[52:55], s71 offen offset:2048 lds
    s_add_u32 s71, s71, 98304
    s_add_u32 s99, s99, 1
    s_cmp_eq_u32 s99, 20
    s_cselect_b32 s11, 1572864, 0
    s_sub_u32 s71, s71, s11
    s_waitcnt vmcnt(21)
    s_barrier
    s_add_u32 m0, s69, 12288
    s_nop 0
    buffer_load_dwordx4 v4, s[52:55], s71 offen offset:0 lds
    buffer_load_dwordx4 v5, s[52:55], s71 offen offset:1024 lds
    buffer_load_dwordx4 v6, s[52:55], s71 offen offset:2048 lds
    s_add_u32 s71, s71, 98304
    s_add_u32 s99, s99, 1
    s_cmp_eq_u32 s99, 20
    s_cselect_b32 s11, 1572864, 0
    s_sub_u32 s71, s71, s11
    s_add_u32 m0, s70, 0
    s_nop 0
    buffer_load_dwordx4 v7, s[48:51], s72 offen offset:0 lds
    buffer_load_dwordx4 v2, s[48:51], s72 offen offset:1024 lds
    s_add_u32 s72, s72, 128
    s_add_u32 s97, s97, 1
    s_cmp_eq_u32 s97, 10
    s_cselect_b32 s11, 1024, 0
    s_sub_u32 s72, s72, s11
    s_waitcnt vmcnt(19)
    s_barrier
    s_add_u32 m0, s70, 0
    s_nop 0
    buffer_load_dwordx4 v7, s[48:51], s73 offen offset:2048 lds
    buffer_load_dwordx4 v2, s[48:51], s73 offen offset:3072 lds
    s_add_u32 s73, s73, 128
    s_add_u32 s98, s98, 1
    s_cmp_eq_u32 s98, 10
    s_cselect_b32 s11, 1024, 0
    s_sub_u32 s73, s73, s11
    s_add_u32 m0, s69, 24576
    s_nop 0
    buffer_load_dwordx4 v4, s[52:55], s71 offen offset:0 lds
    buffer_load_dwordx4 v5, s[52:55], s71 offen offset:1024 lds
    buffer_load_dwordx4 v6, s[52:55], s71 offen offset:2048 lds
    s_add_u32 s71, s71, 98304
    s_add_u32 s99, s99, 1
    s_cmp_eq_u32 s99, 20
    s_cselect_b32 s11, 1572864, 0
    s_sub_u32 s71, s71, s11
    s_waitcnt vmcnt(17)
    s_barrier
    s_add_u32 m0, s69, 36864
    s_nop 0
    buffer_load_dwordx4 v4, s[52:55], s71 offen offset:0 lds
    buffer_load_dwordx4 v5, s[52:55], s71 offen offset:1024 lds
    buffer_load_dwordx4 v6, s[52:55], s71 offen offset:2048 lds
    s_add_u32 s71, s71, 98304
    s_add_u32 s99, s99, 1
    s_cmp_eq_u32 s99, 20
    s_cselect_b32 s11, 1572864, 0
    s_sub_u32 s71, s71, s11
    s_add_u32 m0, s70, 16384
    s_nop 0
    buffer_load_dwordx4 v7, s[48:51], s72 offen offset:0 lds
    buffer_load_dwordx4 v2, s[48:51], s72 offen offset:1024 lds
    s_add_u32 s72, s72, 128
    s_add_u32 s97, s97, 1
    s_cmp_eq_u32 s97, 10
    s_cselect_b32 s11, 1024, 0
    s_sub_u32 s72, s72, s11
    s_waitcnt vmcnt(25)
    v_mov_b32 v160, s10
    v_mov_b32 v161, 0
    s_mov_b64 exec, 1
    buffer_store_dword v160, v161, s[44:47], s78 offen sc1
    s_mov_b64 exec, -1
    s_waitcnt vmcnt(16)
    s_barrier
    s_add_u32 m0, s70, 16384
    s_nop 0
    buffer_load_dwordx4 v7, s[48:51], s73 offen offset:2048 lds
    buffer_load_dwordx4 v2, s[48:51], s73 offen offset:3072 lds
    s_add_u32 s73, s73, 128
    s_add_u32 s98, s98, 1
    s_cmp_eq_u32 s98, 10
    s_cselect_b32 s11, 1024, 0
    s_sub_u32 s73, s73, s11
    s_add_u32 m0, s69, 49152
    s_nop 0
    buffer_load_dwordx4 v4, s[52:55], s71 offen offset:0 lds
    buffer_load_dwordx4 v5, s[52:55], s71 offen offset:1024 lds
    buffer_load_dwordx4 v6, s[52:55], s71 offen offset:2048 lds
    s_add_u32 s71, s71, 98304
    s_add_u32 s99, s99, 1
    s_cmp_eq_u32 s99, 20
    s_cselect_b32 s11, 1572864, 0
    s_sub_u32 s71, s71, s11
    s_waitcnt vmcnt(18)
    s_barrier
    s_add_u32 m0, s69, 61440
    s_nop 0
    buffer_load_dwordx4 v4, s[52:55], s71 offen offset:0 lds
    buffer_load_dwordx4 v5, s[52:55], s71 offen offset:1024 lds
    buffer_load_dwordx4 v6, s[52:55], s71 offen offset:2048 lds
    s_add_u32 s71, s71, 98304
    s_add_u32 s99, s99, 1
    s_cmp_eq_u32 s99, 20
    s_cselect_b32 s11, 1572864, 0
    s_sub_u32 s71, s71, s11
    s_add_u32 m0, s70, 32768
    s_nop 0
    buffer_load_dwordx4 v7, s[48:51], s72 offen offset:0 lds
    buffer_load_dwordx4 v2, s[48:51], s72 offen offset:1024 lds
    s_add_u32 s72, s72, 128
    s_add_u32 s97, s97, 1
    s_cmp_eq_u32 s97, 10
    s_cselect_b32 s11, 1024, 0
    s_sub_u32 s72, s72, s11
    s_waitcnt vmcnt(16)
    s_barrier
    s_add_u32 m0, s70, 32768
    s_nop 0
    buffer_load_dwordx4 v7, s[48:51], s73 offen offset:2048 lds
    buffer_load_dwordx4 v2, s[48:51], s73 offen offset:3072 lds
    s_add_u32 s73, s73, 128
    s_add_u32 s98, s98, 1
    s_cmp_eq_u32 s98, 10
    s_cselect_b32 s11, 1024, 0
    s_sub_u32 s73, s73, s11
    s_add_u32 m0, s69, 0
    s_nop 0
    buffer_load_dwordx4 v4, s[52:55], s71 offen offset:0 lds
    buffer_load_dwordx4 v5, s[52:55], s71 offen offset:1024 lds
    buffer_load_dwordx4 v6, s[52:55], s71 offen offset:2048 lds
    s_add_u32 s71, s71, 98304
    s_add_u32 s99, s99, 1
    s_cmp_eq_u32 s99, 20
    s_cselect_b32 s11, 1572864, 0
    s_sub_u32 s71, s71, s11
    s_waitcnt vmcnt(18)
    s_barrier
    s_add_u32 m0, s69, 12288
    s_nop 0
    buffer_load_dwordx4 v4, s[52:55], s71 offen offset:0 lds
    buffer_load_dwordx4 v5, s[52:55], s71 offen offset:1024 lds
    buffer_load_dwordx4 v6, s[52:55], s71 offen offset:2048 lds
    s_add_u32 s71, s71, 98304
    s_add_u32 s99, s99, 1
    s_cmp_eq_u32 s99, 20
    s_cselect_b32 s11, 1572864, 0
    s_sub_u32 s71, s71, s11
    s_add_u32 m0, s70, 49152
    s_nop 0
    buffer_load_dwordx4 v7, s[48:51], s72 offen offset:0 lds
    buffer_load_dwordx4 v2, s[48:51], s72 offen offset:1024 lds
    s_add_u32 s72, s72, 128
    s_add_u32 s97, s97, 1
    s_cmp_eq_u32 s97, 10
    s_cselect_b32 s11, 1024, 0
    s_sub_u32 s72, s72, s11
    s_waitcnt vmcnt(15)
    s_barrier
    s_add_u32 m0, s70, 49152
    s_nop 0
    buffer_load_dwordx4 v7, s[48:51], s73 offen offset:2048 lds
    buffer_load_dwordx4 v2, s[48:51], s73 offen offset:3072 lds
    s_add_u32 s73, s73, 128
    s_add_u32 s98, s98, 1
    s_cmp_eq_u32 s98, 10
    s_cselect_b32 s11, 1024, 0
    s_sub_u32 s73, s73, s11
    s_add_u32 m0, s69, 24576
    s_nop 0
    buffer_load_dwordx4 v4, s[52:55], s71 offen offset:0 lds
    buffer_load_dwordx4 v5, s[52:55], s71 offen offset:1024 lds
    buffer_load_dwordx4 v6, s[52:55], s71 offen offset:2048 lds
    s_add_u32 s71, s71, 98304
    s_add_u32 s99, s99, 1
    s_cmp_eq_u32 s99, 20
    s_cselect_b32 s11, 1572864, 0
    s_sub_u32 s71, s71, s11
    s_waitcnt vmcnt(17)
    s_barrier
    s_add_u32 m0, s69, 36864
    s_nop 0
    buffer_load_dwordx4 v4, s[52:55], s71 offen offset:0 lds
    buffer_load_dwordx4 v5, s[52:55], s71 offen offset:1024 lds
    buffer_load_dwordx4 v6, s[52:55], s71 offen offset:2048 lds
    s_add_u32 s71, s71, 98304
    s_add_u32 s99, s99, 1
    s_cmp_eq_u32 s99, 20
    s_cselect_b32 s11, 1572864, 0
    s_sub_u32 s71, s71, s11
    s_add_u32 m0, s70, 0
    s_nop 0
    buffer_load_dwordx4 v7, s[48:51], s72 offen offset:0 lds
    buffer_load_dwordx4 v2, s[48:51], s72 offen offset:1024 lds
    s_add_u32 s72, s72, 128
    s_add_u32 s97, s97, 1
    s_cmp_eq_u32 s97, 10
    s_cselect_b32 s11, 1024, 0
    s_sub_u32 s72, s72, s11
    s_waitcnt vmcnt(15)
    s_barrier
    s_add_u32 m0, s70, 0
    s_nop 0
    buffer_load_dwordx4 v7, s[48:51], s73 offen offset:2048 lds
    buffer_load_dwordx4 v2, s[48:51], s73 offen offset:3072 lds
    s_add_u32 s73, s73, 128
    s_add_u32 s98, s98, 1
    s_cmp_eq_u32 s98, 10
    s_cselect_b32 s11, 1024, 0
    s_sub_u32 s73, s73, s11
    s_add_u32 m0, s69, 49152
    s_nop 0
    buffer_load_dwordx4 v4, s[52:55], s71 offen offset:0 lds
    buffer_load_dwordx4 v5, s[52:55], s71 offen offset:1024 lds
    buffer_load_dwordx4 v6, s[52:55], s71 offen offset:2048 lds
    s_add_u32 s71, s71, 98304
    s_add_u32 s99, s99, 1
    s_cmp_eq_u32 s99, 20
    s_cselect_b32 s11, 1572864, 0
    s_sub_u32 s71, s71, s11
    s_waitcnt vmcnt(17)
    s_barrier
    s_add_u32 m0, s69, 61440
    s_nop 0
    buffer_load_dwordx4 v4, s[52:55], s71 offen offset:0 lds
    buffer_load_dwordx4 v5, s[52:55], s71 offen offset:1024 lds
    buffer_load_dwordx4 v6, s[52:55], s71 offen offset:2048 lds
    s_add_u32 s71, s71, 98304
    s_add_u32 s99, s99, 1
    s_cmp_eq_u32 s99, 20
    s_cselect_b32 s11, 1572864, 0
    s_sub_u32 s71, s71, s11
    s_add_u32 m0, s70, 16384
    s_nop 0
    buffer_load_dwordx4 v7, s[48:51], s72 offen offset:0 lds
    buffer_load_dwordx4 v2, s[48:51], s72 offen offset:1024 lds
    s_add_u32 s72, s72, 128
    s_add_u32 s97, s97, 1
    s_cmp_eq_u32 s97, 10
    s_cselect_b32 s11, 1024, 0
    s_sub_u32 s72, s72, s11
    s_waitcnt vmcnt(15)
    s_barrier
    s_add_u32 m0, s70, 16384
    s_nop 0
    buffer_load_dwordx4 v7, s[48:51], s73 offen offset:2048 lds
    buffer_load_dwordx4 v2, s[48:51], s73 offen offset:3072 lds
    s_add_u32 s73, s73, 128
    s_add_u32 s98, s98, 1
    s_cmp_eq_u32 s98, 10
    s_cselect_b32 s11, 1024, 0
    s_sub_u32 s73, s73, s11
    s_add_u32 m0, s69, 0
    s_nop 0
    buffer_load_dwordx4 v4, s[52:55], s71 offen offset:0 lds
    buffer_load_dwordx4 v5, s[52:55], s71 offen offset:1024 lds
    buffer_load_dwordx4 v6, s[52:55], s71 offen offset:2048 lds
    s_add_u32 s71, s71, 98304
    s_add_u32 s99, s99, 1
    s_cmp_eq_u32 s99, 20
    s_cselect_b32 s11, 1572864, 0
    s_sub_u32 s71, s71, s11
    s_waitcnt vmcnt(17)
    s_barrier
    s_add_u32 m0, s69, 12288
    s_nop 0
    buffer_load_dwordx4 v4, s[52:55], s71 offen offset:0 lds
    buffer_load_dwordx4 v5, s[52:55], s71 offen offset:1024 lds
    buffer_load_dwordx4 v6, s[52:55], s71 offen offset:2048 lds
    s_add_u32 s71, s71, 98304
    s_add_u32 s99, s99, 1
    s_cmp_eq_u32 s99, 20
    s_cselect_b32 s11, 1572864, 0
    s_sub_u32 s71, s71, s11
    s_waitcnt vmcnt(13)
    s_barrier
    s_waitcnt vmcnt(10)
    s_barrier
    s_cmp_eq_u32 s77, 0
    s_cselect_b32 s12, 2147483648, 0
    v_add_u32 v8, s12, v8
    v_add_u32 v9, s12, v9
    s_lshl_b32 s79, s74, 12
    s_add_u32 m0, s75, 32
    v_mov_b32 v12, 0
    v_mov_b32 v13, 0
    buffer_load_dwordx4 v8, s[84:87], s79 offen offset:0  lds
    buffer_load_dwordx4 v8, s[84:87], s79 offen offset:1024  lds
    buffer_load_dwordx4 v8, s[84:87], s79 offen offset:2048  lds
    buffer_load_dwordx4 v8, s[84:87], s79 offen offset:3072  lds
    s_add_u32 m0, s75, 4192
    s_nop 0
    buffer_load_dwordx4 v9, s[84:87], s79 offen offset:0  lds
    buffer_load_dwordx4 v9, s[84:87], s79 offen offset:1024  lds
    s_waitcnt vmcnt(9)
    s_barrier
    buffer_load_dwordx4 v9, s[84:87], s79 offen offset:2048  lds
    buffer_load_dwordx4 v9, s[84:87], s79 offen offset:3072  lds
    v_lshlrev_b32 v10, 3, v1
    v_add_u32 v10, s75, v10
    ds_write_b64 v10, v[12:13] offset:12416
    v_and_b32 v11, 3, v1
    v_lshlrev_b32 v11, 3, v11
    v_add_u32 v11, s75, v11
    ds_write_b64 v11, v[12:13] offset:0
    ds_write_b64 v11, v[12:13] offset:4160
    ds_read_b32 v152, v0 offset:32
    s_add_u32 s79, s79, 1048576
    s_waitcnt vmcnt(8)
    s_barrier
    s_waitcnt lgkmcnt(0)
    v_readfirstlane_b32 s94, v152
    s_cmp_eq_u32 s94, 0
    s_cbranch_scc1 L_xr_skip
    s_add_u32 m0, s75, 8320
    s_nop 0
    buffer_load_dwordx4 v8, s[44:47], s79 offen offset:0 sc1 lds
    buffer_load_dwordx4 v8, s[44:47], s79 offen offset:1024 sc1 lds
    buffer_load_dwordx4 v8, s[44:47], s79 offen offset:2048 sc1 lds
    buffer_load_dwordx4 v8, s[44:47], s79 offen offset:3072 sc1 lds
L_xr_skip:
    s_barrier
    s_barrier
    s_setprio 0
    s_cmp_eq_u32 s77, 0
    s_cbranch_scc1 L_end
    s_cmp_lg_u32 s94, 0
    s_cbranch_scc1 L_xr_done
    s_mov_b32 s12, 1048576
    s_branch L_ls1_rd
L_ls1:
    s_sleep 1
L_ls1_rd:
    ds_read_b32 v148, v0 offset:32
    s_waitcnt lgkmcnt(0)
    v_readfirstlane_b32 s11, v148
    s_sub_u32 s12, s12, 1
    s_cselect_b32 s11, -1, s11
    s_cmp_lt_u32 s11, 1
    s_cbranch_scc1 L_ls1
    s_add_u32 m0, s75, 8320
    s_nop 0
    buffer_load_dwordx4 v8, s[44:47], s79 offen offset:0 sc1 lds
    buffer_load_dwordx4 v8, s[44:47], s79 offen offset:1024 sc1 lds
    buffer_load_dwordx4 v8, s[44:47], s79 offen offset:2048 sc1 lds
    buffer_load_dwordx4 v8, s[44:47], s79 offen offset:3072 sc1 lds
L_xr_done:
    s_waitcnt vmcnt(4)
    v_mov_b32 v10, s75
    ds_read_b32 v11, v10 offset:32
    s_waitcnt lgkmcnt(0)
    v_lshlrev_b32 v11, 16, v11
    ds_write_b32 v10, v11 offset:4188
    s_waitcnt vmcnt(0)
    ds_read2_b32 v[64:65], v16 offset0:0 offset1:1
    ds_read2_b32 v[66:67], v16 offset0:2 offset1:3
    ds_read_b128 v[96:99], v20 offset:3584
    ds_read_b128 v[100:103], v20 offset:3072
    ds_read_b128 v[104:107], v20 offset:2560
    ds_read_b128 v[108:111], v20 offset:2048
    ds_read_b128 v[112:115], v20 offset:1536
    ds_read_b128 v[116:119], v20 offset:1024
    ds_read_b128 v[120:123], v20 offset:512
    ds_read_b128 v[124:127], v20 offset:0
    ds_read2_b32 v[68:69], v16 offset0:128 offset1:129
    ds_read2_b32 v[70:71], v16 offset0:130 offset1:131
    ds_read2_b32 v[72:73], v17 offset0:0 offset1:1
    ds_read2_b32 v[74:75], v17 offset0:2 offset1:3
    ds_read2_b32 v[76:77], v17 offset0:128 offset1:129
    ds_read2_b32 v[78:79], v17 offset0:130 offset1:131
    ds_read2_b32 v[80:81], v18 offset0:0 offset1:1
    ds_read2_b32 v[82:83], v18 offset0:2 offset1:3
    ds_read2_b32 v[84:85], v18 offset0:128 offset1:129
    ds_read2_b32 v[86:87], v18 offset0:130 offset1:131
    ds_read2_b32 v[88:89], v19 offset0:0 offset1:1
    ds_read2_b32 v[90:91], v19 offset0:2 offset1:3
    ds_read2_b32 v[92:93], v19 offset0:128 offset1:129
    ds_read2_b32 v[94:95], v19 offset0:130 offset1:131
    s_mov_b32 s11, 4
L_conv:
    s_waitcnt lgkmcnt(0)
    v_mfma_f32_16x16x32_bf16 v[32:35], v[64:67], v[96:99], v[32:35]
    ds_read2_b32 v[128:129], v16 offset0:16 offset1:17
    v_mfma_f32_16x16x32_bf16 v[36:39], v[64:67], v[100:103], v[36:39]
    ds_read2_b32 v[130:131], v16 offset0:18 offset1:19
    v_mfma_f32_16x16x32_bf16 v[40:43], v[64:67], v[104:107], v[40:43]
    ds_read_b128 v[160:163], v20 offset:3648
    v_mfma_f32_16x16x32_bf16 v[44:47], v[64:67], v[108:111], v[44:47]
    ds_read_b128 v[164:167], v20 offset:3136
    v_mfma_f32_16x16x32_bf16 v[48:51], v[64:67], v[112:115], v[48:51]
    ds_read_b128 v[168:171], v20 offset:2624
    v_mfma_f32_16x16x32_bf16 v[52:55], v[64:67], v[116:119], v[52:55]
    ds_read_b128 v[172:175], v20 offset:2112
    v_mfma_f32_16x16x32_bf16 v[56:59], v[64:67], v[120:123], v[56:59]
    ds_read_b128 v[176:179], v20 offset:1600
    v_mfma_f32_16x16x32_bf16 v[60:63], v[64:67], v[124:127], v[60:63]
    ds_read_b128 v[180:183], v20 offset:1088
    v_mfma_f32_16x16x32_bf16 v[36:39], v[68:71], v[96:99], v[36:39]
    ds_read_b128 v[184:187], v20 offset:576
    v_mfma_f32_16x16x32_bf16 v[40:43], v[68:71], v[100:103], v[40:43]
    ds_read_b128 v[188:191], v20 offset:64
    v_mfma_f32_16x16x32_bf16 v[44:47], v[68:71], v[104:107], v[44:47]
    ds_read2_b32 v[132:133], v16 offset0:144 offset1:145
    v_mfma_f32_16x16x32_bf16 v[48:51], v[68:71], v[108:111], v[48:51]
    ds_read2_b32 v[134:135], v16 offset0:146 offset1:147
    v_mfma_f32_16x16x32_bf16 v[52:55], v[68:71], v[112:115], v[52:55]
    ds_read2_b32 v[136:137], v17 offset0:16 offset1:17
    v_mfma_f32_16x16x32_bf16 v[56:59], v[68:71], v[116:119], v[56:59]
    ds_read2_b32 v[138:139], v17 offset0:18 offset1:19
    v_mfma_f32_16x16x32_bf16 v[60:63], v[68:71], v[120:123], v[60:63]
    ds_read2_b32 v[140:141], v17 offset0:144 offset1:145
    v_mfma_f32_16x16x32_bf16 v[40:43], v[72:75], v[96:99], v[40:43]
    ds_read2_b32 v[142:143], v17 offset0:146 offset1:147
    v_mfma_f32_16x16x32_bf16 v[44:47], v[72:75], v[100:103], v[44:47]
    ds_read2_b32 v[144:145], v18 offset0:16 offset1:17
    v_mfma_f32_16x16x32_bf16 v[48:51], v[72:75], v[104:107], v[48:51]
    ds_read2_b32 v[146:147], v18 offset0:18 offset1:19
    v_mfma_f32_16x16x32_bf16 v[52:55], v[72:75], v[108:111], v[52:55]
    ds_read2_b32 v[148:149], v18 offset0:144 offset1:145
    v_mfma_f32_16x16x32_bf16 v[56:59], v[72:75], v[112:115], v[56:59]
    ds_read2_b32 v[150:151], v18 offset0:146 offset1:147
    v_mfma_f32_16x16x32_bf16 v[60:63], v[72:75], v[116:119], v[60:63]
    ds_read2_b32 v[152:153], v19 offset0:16 offset1:17
    v_mfma_f32_16x16x32_bf16 v[44:47], v[76:79], v[96:99], v[44:47]
    ds_read2_b32 v[154:155], v19 offset0:18 offset1:19
    v_mfma_f32_16x16x32_bf16 v[48:51], v[76:79], v[100:103], v[48:51]
    ds_read2_b32 v[156:157], v19 offset0:144 offset1:145
    v_mfma_f32_16x16x32_bf16 v[52:55], v[76:79], v[104:107], v[52:55]
    ds_read2_b32 v[158:159], v19 offset0:146 offset1:147
    v_mfma_f32_16x16x32_bf16 v[56:59], v[76:79], v[108:111], v[56:59]
    v_mfma_f32_16x16x32_bf16 v[60:63], v[76:79], v[112:115], v[60:63]
    v_mfma_f32_16x16x32_bf16 v[48:51], v[80:83], v[96:99], v[48:51]
    v_mfma_f32_16x16x32_bf16 v[52:55], v[80:83], v[100:103], v[52:55]
    v_mfma_f32_16x16x32_bf16 v[56:59], v[80:83], v[104:107], v[56:59]
    v_mfma_f32_16x16x32_bf16 v[60:63], v[80:83], v[108:111], v[60:63]
    v_mfma_f32_16x16x32_bf16 v[52:55], v[84:87], v[96:99], v[52:55]
    v_mfma_f32_16x16x32_bf16 v[56:59], v[84:87], v[100:103], v[56:59]
    v_mfma_f32_16x16x32_bf16 v[60:63], v[84:87], v[104:107], v[60:63]
    v_mfma_f32_16x16x32_bf16 v[56:59], v[88:91], v[96:99], v[56:59]
    v_mfma_f32_16x16x32_bf16 v[60:63], v[88:91], v[100:103], v[60:63]
    v_mfma_f32_16x16x32_bf16 v[60:63], v[92:95], v[96:99], v[60:63]
    s_waitcnt lgkmcnt(0)
    v_add_u32 v16, 128, v16
    v_add_u32 v17, 128, v17
    v_add_u32 v18, 128, v18
    v_add_u32 v19, 128, v19
    v_add_u32 v20, 128, v20
    v_mfma_f32_16x16x32_bf16 v[32:35], v[128:131], v[160:163], v[32:35]
    ds_read2_b32 v[64:65], v16 offset0:0 offset1:1
    v_mfma_f32_16x16x32_bf16 v[36:39], v[128:131], v[164:167], v[36:39]
    ds_read2_b32 v[66:67], v16 offset0:2 offset1:3
    v_mfma_f32_16x16x32_bf16 v[40:43], v[128:131], v[168:171], v[40:43]
    ds_read_b128 v[96:99], v20 offset:3584
    v_mfma_f32_16x16x32_bf16 v[44:47], v[128:131], v[172:175], v[44:47]
    ds_read_b128 v[100:103], v20 offset:3072
    v_mfma_f32_16x16x32_bf16 v[48:51], v[128:131], v[176:179], v[48:51]
    ds_read_b128 v[104:107], v20 offset:2560
    v_mfma_f32_16x16x32_bf16 v[52:55], v[128:131], v[180:183], v[52:55]
    ds_read_b128 v[108:111], v20 offset:2048
    v_mfma_f32_16x16x32_bf16 v[56:59], v[128:131], v[184:187], v[56:59]
    ds_read_b128 v[112:115], v20 offset:1536
    v_mfma_f32_16x16x32_bf16 v[60:63], v[128:131], v[188:191], v[60:63]
    ds_read_b128 v[116:119], v20 offset:1024
    v_mfma_f32_16x16x32_bf16 v[36:39], v[132:135], v[160:163], v[36:39]
    ds_read_b128 v[120:123], v20 offset:512
    v_mfma_f32_16x16x32_bf16 v[40:43], v[132:135], v[164:167], v[40:43]
    ds_read_b128 v[124:127], v20 offset:0
    v_mfma_f32_16x16x32_bf16 v[44:47], v[132:135], v[168:171], v[44:47]
    ds_read2_b32 v[68:69], v16 offset0:128 offset1:129
    v_mfma_f32_16x16x32_bf16 v[48:51], v[132:135], v[172:175], v[48:51]
    ds_read2_b32 v[70:71], v16 offset0:130 offset1:131
    v_mfma_f32_16x16x32_bf16 v[52:55], v[132:135], v[176:179], v[52:55]
    ds_read2_b32 v[72:73], v17 offset0:0 offset1:1
    v_mfma_f32_16x16x32_bf16 v[56:59], v[132:135], v[180:183], v[56:59]
    ds_read2_b32 v[74:75], v17 offset0:2 offset1:3
    v_mfma_f32_16x16x32_bf16 v[60:63], v[132:135], v[184:187], v[60:63]
    ds_read2_b32 v[76:77], v17 offset0:128 offset1:129
    v_mfma_f32_16x16x32_bf16 v[40:43], v[136:139], v[160:163], v[40:43]
    ds_read2_b32 v[78:79], v17 offset0:130 offset1:131
    v_mfma_f32_16x16x32_bf16 v[44:47], v[136:139], v[164:167], v[44:47]
    ds_read2_b32 v[80:81], v18 offset0:0 offset1:1
    v_mfma_f32_16x16x32_bf16 v[48:51], v[136:139], v[168:171], v[48:51]
    ds_read2_b32 v[82:83], v18 offset0:2 offset1:3
    v_mfma_f32_16x16x32_bf16 v[52:55], v[136:139], v[172:175], v[52:55]
    ds_read2_b32 v[84:85], v18 offset0:128 offset1:129
    v_mfma_f32_16x16x32_bf16 v[56:59], v[136:139], v[176:179], v[56:59]
    ds_read2_b32 v[86:87], v18 offset0:130 offset1:131
    v_mfma_f32_16x16x32_bf16 v[60:63], v[136:139], v[180:183], v[60:63]
    ds_read2_b32 v[88:89], v19 offset0:0 offset1:1
    v_mfma_f32_16x16x32_bf16 v[44:47], v[140:143], v[160:163], v[44:47]
    ds_read2_b32 v[90:91], v19 offset0:2 offset1:3
    v_mfma_f32_16x16x32_bf16 v[48:51], v[140:143], v[164:167], v[48:51]
    ds_read2_b32 v[92:93], v19 offset0:128 offset1:129
    v_mfma_f32_16x16x32_bf16 v[52:55], v[140:143], v[168:171], v[52:55]
    ds_read2_b32 v[94:95], v19 offset0:130 offset1:131
    v_mfma_f32_16x16x32_bf16 v[56:59], v[140:143], v[172:175], v[56:59]
    v_mfma_f32_16x16x32_bf16 v[60:63], v[140:143], v[176:179], v[60:63]
    v_mfma_f32_16x16x32_bf16 v[48:51], v[144:147], v[160:163], v[48:51]
    v_mfma_f32_16x16x32_bf16 v[52:55], v[144:147], v[164:167], v[52:55]
    v_mfma_f32_16x16x32_bf16 v[56:59], v[144:147], v[168:171], v[56:59]
    v_mfma_f32_16x16x32_bf16 v[60:63], v[144:147], v[172:175], v[60:63]
    v_mfma_f32_16x16x32_bf16 v[52:55], v[148:151], v[160:163], v[52:55]
    v_mfma_f32_16x16x32_bf16 v[56:59], v[148:151], v[164:167], v[56:59]
    v_mfma_f32_16x16x32_bf16 v[60:63], v[148:151], v[168:171], v[60:63]
    v_mfma_f32_16x16x32_bf16 v[56:59], v[152:155], v[160:163], v[56:59]
    v_mfma_f32_16x16x32_bf16 v[60:63], v[152:155], v[164:167], v[60:63]
    v_mfma_f32_16x16x32_bf16 v[60:63], v[156:159], v[160:163], v[60:63]
    s_sub_u32 s11, s11, 1
    s_cmp_lg_u32 s11, 0
    s_cbranch_scc1 L_conv
L_skipconv:
    s_setprio 3
    s_waitcnt lgkmcnt(0)
    ds_read_b64 v[64:65], v21 offset:3584
    ds_read_b64 v[66:67], v21 offset:3072
    ds_read_b64 v[68:69], v21 offset:2560
    ds_read_b64 v[70:71], v21 offset:2048
    ds_read_b64 v[72:73], v21 offset:1536
    ds_read_b64 v[74:75], v21 offset:1024
    ds_read_b64 v[76:77], v21 offset:512
    ds_read_b64 v[78:79], v21 offset:0
    s_lshl_b32 s13, s74, 12
    s_add_u32 s13, s13, 12582912
    s_lshl_b32 s14, s74, 2
    s_add_u32 s14, s14, 24576
    s_waitcnt lgkmcnt(7)
    v_and_b32 v96, s101, v65
    v_lshlrev_b32 v97, 16, v65
    v_and_b32 v98, s101, v64
    v_lshlrev_b32 v99, 16, v64
    v_fmac_f32 v32, s76, v96
    v_fmac_f32 v33, s76, v97
    v_fmac_f32 v34, s76, v98
    v_fmac_f32 v35, s76, v99
    v_cvt_pk_bf16_f32 v64, v32, v33
    v_cvt_pk_bf16_f32 v65, v34, v35
    ds_write_b64 v22, v[64:65] offset:0
    s_waitcnt lgkmcnt(7)
    v_and_b32 v96, s101, v67
    v_lshlrev_b32 v97, 16, v67
    v_and_b32 v98, s101, v66
    v_lshlrev_b32 v99, 16, v66
    v_fmac_f32 v36, s76, v96
    v_fmac_f32 v37, s76, v97
    v_fmac_f32 v38, s76, v98
    v_fmac_f32 v39, s76, v99
    v_cvt_pk_bf16_f32 v66, v36, v37
    v_cvt_pk_bf16_f32 v67, v38, v39
    ds_write_b64 v22, v[66:67] offset:512
    s_waitcnt lgkmcnt(7)
    v_and_b32 v96, s101, v69
    v_lshlrev_b32 v97, 16, v69
    v_and_b32 v98, s101, v68
    v_lshlrev_b32 v99, 16, v68
    v_fmac_f32 v40, s76, v96
    v_fmac_f32 v41, s76, v97
    v_fmac_f32 v42, s76, v98
    v_fmac_f32 v43, s76, v99
    v_cvt_pk_bf16_f32 v68, v40, v41
    v_cvt_pk_bf16_f32 v69, v42, v43
    ds_write_b64 v22, v[68:69] offset:1024
    s_waitcnt lgkmcnt(7)
    v_and_b32 v96, s101, v71
    v_lshlrev_b32 v97, 16, v71
    v_and_b32 v98, s101, v70
    v_lshlrev_b32 v99, 16, v70
    v_fmac_f32 v44, s76, v96
    v_fmac_f32 v45, s76, v97
    v_fmac_f32 v46, s76, v98
    v_fmac_f32 v47, s76, v99
    v_cvt_pk_bf16_f32 v70, v44, v45
    v_cvt_pk_bf16_f32 v71, v46, v47
    ds_write_b64 v22, v[70:71] offset:1536
    s_waitcnt lgkmcnt(7)
    v_and_b32 v96, s101, v73
    v_lshlrev_b32 v97, 16, v73
    v_and_b32 v98, s101, v72
    v_lshlrev_b32 v99, 16, v72
    v_fmac_f32 v48, s76, v96
    v_fmac_f32 v49, s76, v97
    v_fmac_f32 v50, s76, v98
    v_fmac_f32 v51, s76, v99
    v_cvt_pk_bf16_f32 v72, v48, v49
    v_cvt_pk_bf16_f32 v73, v50, v51
    ds_write_b64 v22, v[72:73] offset:2048
    s_waitcnt lgkmcnt(7)
    v_and_b32 v96, s101, v75
    v_lshlrev_b32 v97, 16, v75
    v_and_b32 v98, s101, v74
    v_lshlrev_b32 v99, 16, v74
    v_fmac_f32 v52, s76, v96
    v_fmac_f32 v53, s76, v97
    v_fmac_f32 v54, s76, v98
    v_fmac_f32 v55, s76, v99
    v_cvt_pk_bf16_f32 v74, v52, v53
    v_cvt_pk_bf16_f32 v75, v54, v55
    ds_write_b64 v22, v[74:75] offset:2560
    s_waitcnt lgkmcnt(7)
    v_and_b32 v96, s101, v77
    v_lshlrev_b32 v97, 16, v77
    v_and_b32 v98, s101, v76
    v_lshlrev_b32 v99, 16, v76
    v_fmac_f32 v56, s76, v96
    v_fmac_f32 v57, s76, v97
    v_fmac_f32 v58, s76, v98
    v_fmac_f32 v59, s76, v99
    v_cvt_pk_bf16_f32 v76, v56, v57
    v_cvt_pk_bf16_f32 v77, v58, v59
    ds_write_b64 v22, v[76:77] offset:3072
    s_waitcnt lgkmcnt(7)
    v_and_b32 v96, s101, v79
    v_lshlrev_b32 v97, 16, v79
    v_and_b32 v98, s101, v78
    v_lshlrev_b32 v99, 16, v78
    v_fmac_f32 v60, s76, v96
    v_fmac_f32 v61, s76, v97
    v_fmac_f32 v62, s76, v98
    v_fmac_f32 v63, s76, v99
    v_cvt_pk_bf16_f32 v78, v60, v61
    v_cvt_pk_bf16_f32 v79, v62, v63
    ds_write_b64 v22, v[78:79] offset:3584
    s_waitcnt lgkmcnt(0)
    ds_read_b128 v[96:99], v23 offset:0
    ds_read_b128 v[100:103], v23 offset:1024
    ds_read_b128 v[104:107], v23 offset:2048
    ds_read_b128 v[108:111], v23 offset:3072
    s_waitcnt lgkmcnt(3)
    buffer_store_dwordx4 v[96:99], v8, s[44:47], s13 offen offset:0 sc1
    s_waitcnt lgkmcnt(2)
    buffer_store_dwordx4 v[100:103], v8, s[44:47], s13 offen offset:1024 sc1
    s_waitcnt lgkmcnt(1)
    buffer_store_dwordx4 v[104:107], v8, s[44:47], s13 offen offset:2048 sc1
    s_waitcnt lgkmcnt(0)
    buffer_store_dwordx4 v[108:111], v8, s[44:47], s13 offen offset:3072 sc1
    s_waitcnt vmcnt(0)
    v_mov_b32 v12, s10
    v_mov_b32 v13, 0
    s_mov_b64 exec, 1
    buffer_store_dword v12, v13, s[44:47], s14 offen sc1
    s_mov_b64 exec, -1
    s_endpgm
L_svc:
    s_mov_b64 s[60:61], s[36:37]
    s_mov_b32 s62, 1280
    s_mov_b32 s63, 0x20000
    v_mov_b32 v8, 0
    v_mov_b32 v9, 0
    v_mov_b32 v10, 0
    v_mov_b32 v11, 0
    s_mov_b64 exec, 1
    ds_write_b128 v0, v[8:11] offset:32
    ds_write_b128 v0, v[8:11]
    ds_write_b128 v0, v[8:11] offset:16
    s_mov_b64 exec, -1
    v_lshlrev_b32 v8, 4, v1
    s_mov_b32 m0, 162176
    s_nop 0
    buffer_load_dwordx4 v8, s[60:63], 0 offen lds
    s_mov_b64 exec, 0xffff
    buffer_load_dwordx4 v8, s[60:63], 0 offen offset:1024 lds
    s_mov_b64 exec, -1
    s_lshr_b32 s11, s7, 1
    s_lshl_b32 s11, s11, 4
    v_and_b32 v10, 15, v1
    v_add_u32 v10, s11, v10
    v_lshrrev_b32 v11, 4, v1
    v_lshlrev_b32 v137, 4, v11
    v_add_u32 v137, 162176, v137
    v_bfe_u32 v12, v10, 1, 3
    v_xor_b32 v11, v11, v12
    v_lshlrev_b32 v11, 4, v11
    v_lshl_add_u32 v11, v10, 7, v11
    v_add_u32 v136, 73728, v11
    v_xor_b32 v138, 64, v136
    v_mov_b32 v140, 0
    v_mov_b32 v141, 0
    v_mov_b32 v142, 0
    v_mov_b32 v143, 0
    s_mov_b32 s93, 0
    v_bfe_u32 v115, v1, 4, 1
    v_bfe_u32 v116, v1, 2, 2
    v_lshl_add_u32 v116, v115, 2, v116
    v_mul_u32_u24 v116, 160, v116
    v_lshrrev_b32 v117, 5, v1
    v_lshl_add_u32 v116, v117, 5, v116
    v_and_b32 v112, 3, v1
    v_lshl_add_u32 v116, v112, 3, v116
    v_add_u32 v116, 150784, v116
    v_and_b32 v112, 15, v1
    v_lshl_add_u32 v112, v115, 4, v112
    v_lshlrev_b32 v112, 4, v112
    v_lshl_add_u32 v112, v117, 10, v112
    v_cmp_gt_u32 vcc, 32, v1
    v_mov_b32 v113, 2147483648
    s_nop 0
    v_cndmask_b32 v113, v113, v112, vcc
    s_mov_b64 s[56:57], s[34:35]
    s_mov_b32 s58, 1966080
    s_mov_b32 s59, 0x20000
    s_mul_i32 s13, s8, 3
    s_mul_i32 s91, s9, 160
    s_movk_i32 s12, 1280
    v_add_u32 v126, 0, v1
    v_mul_u32_u24 v127, 6554, v126
    v_lshrrev_b32 v127, 16, v127
    v_mul_u32_u24 v128, 10, v127
    v_sub_u32 v128, v126, v128
    v_lshlrev_b32 v128, 4, v128
    v_lshrrev_b32 v129, 4, v127
    v_add_u32 v129, s13, v129
    v_and_b32 v130, 1, v129
    v_lshrrev_b32 v129, 1, v129
    v_lshlrev_b32 v129, 2, v129
    v_add_u32 v129, v129, v130
    v_bfe_u32 v130, v127, 3, 1
    v_lshl_add_u32 v129, v130, 1, v129
    v_and_b32 v127, 7, v127
    v_lshl_add_u32 v127, v129, 3, v127
    v_mad_u32_u24 v104, v127, s12, v128
    v_add_u32 v126, 64, v1
    v_mul_u32_u24 v127, 6554, v126
    v_lshrrev_b32 v127, 16, v127
    v_mul_u32_u24 v128, 10, v127
    v_sub_u32 v128, v126, v128
    v_lshlrev_b32 v128, 4, v128
    v_lshrrev_b32 v129, 4, v127
    v_add_u32 v129, s13, v129
    v_and_b32 v130, 1, v129
    v_lshrrev_b32 v129, 1, v129
    v_lshlrev_b32 v129, 2, v129
    v_add_u32 v129, v129, v130
    v_bfe_u32 v130, v127, 3, 1
    v_lshl_add_u32 v129, v130, 1, v129
    v_and_b32 v127, 7, v127
    v_lshl_add_u32 v127, v129, 3, v127
    v_mad_u32_u24 v105, v127, s12, v128
    v_add_u32 v126, 128, v1
    v_mul_u32_u24 v127, 6554, v126
    v_lshrrev_b32 v127, 16, v127
    v_mul_u32_u24 v128, 10, v127
    v_sub_u32 v128, v126, v128
    v_lshlrev_b32 v128, 4, v128
    v_lshrrev_b32 v129, 4, v127
    v_add_u32 v129, s13, v129
    v_and_b32 v130, 1, v129
    v_lshrrev_b32 v129, 1, v129
    v_lshlrev_b32 v129, 2, v129
    v_add_u32 v129, v129, v130
    v_bfe_u32 v130, v127, 3, 1
    v_lshl_add_u32 v129, v130, 1, v129
    v_and_b32 v127, 7, v127
    v_lshl_add_u32 v127, v129, 3, v127
    v_mad_u32_u24 v106, v127, s12, v128
    v_add_u32 v126, 192, v1
    v_mul_u32_u24 v127, 6554, v126
    v_lshrrev_b32 v127, 16, v127
    v_mul_u32_u24 v128, 10, v127
    v_sub_u32 v128, v126, v128
    v_lshlrev_b32 v128, 4, v128
    v_lshrrev_b32 v129, 4, v127
    v_add_u32 v129, s13, v129
    v_and_b32 v130, 1, v129
    v_lshrrev_b32 v129, 1, v129
    v_lshlrev_b32 v129, 2, v129
    v_add_u32 v129, v129, v130
    v_bfe_u32 v130, v127, 3, 1
    v_lshl_add_u32 v129, v130, 1, v129
    v_and_b32 v127, 7, v127
    v_lshl_add_u32 v127, v129, 3, v127
    v_mad_u32_u24 v107, v127, s12, v128
    v_add_u32 v126, 256, v1
    v_mul_u32_u24 v127, 6554, v126
    v_lshrrev_b32 v127, 16, v127
    v_mul_u32_u24 v128, 10, v127
    v_sub_u32 v128, v126, v128
    v_lshlrev_b32 v128, 4, v128
    v_lshrrev_b32 v129, 4, v127
    v_add_u32 v129, s13, v129
    v_and_b32 v130, 1, v129
    v_lshrrev_b32 v129, 1, v129
    v_lshlrev_b32 v129, 2, v129
    v_add_u32 v129, v129, v130
    v_bfe_u32 v130, v127, 3, 1
    v_lshl_add_u32 v129, v130, 1, v129
    v_and_b32 v127, 7, v127
    v_lshl_add_u32 v127, v129, 3, v127
    v_mad_u32_u24 v108, v127, s12, v128
    v_add_u32 v126, 320, v1
    v_mul_u32_u24 v127, 6554, v126
    v_lshrrev_b32 v127, 16, v127
    v_mul_u32_u24 v128, 10, v127
    v_sub_u32 v128, v126, v128
    v_lshlrev_b32 v128, 4, v128
    v_lshrrev_b32 v129, 4, v127
    v_add_u32 v129, s13, v129
    v_and_b32 v130, 1, v129
    v_lshrrev_b32 v129, 1, v129
    v_lshlrev_b32 v129, 2, v129
    v_add_u32 v129, v129, v130
    v_bfe_u32 v130, v127, 3, 1
    v_lshl_add_u32 v129, v130, 1, v129
    v_and_b32 v127, 7, v127
    v_lshl_add_u32 v127, v129, 3, v127
    v_mad_u32_u24 v109, v127, s12, v128
    v_add_u32 v126, 384, v1
    v_mul_u32_u24 v127, 6554, v126
    v_lshrrev_b32 v127, 16, v127
    v_mul_u32_u24 v128, 10, v127
    v_sub_u32 v128, v126, v128
    v_lshlrev_b32 v128, 4, v128
    v_lshrrev_b32 v129, 4, v127
    v_add_u32 v129, s13, v129
    v_and_b32 v130, 1, v129
    v_lshrrev_b32 v129, 1, v129
    v_lshlrev_b32 v129, 2, v129
    v_add_u32 v129, v129, v130
    v_bfe_u32 v130, v127, 3, 1
    v_lshl_add_u32 v129, v130, 1, v129
    v_and_b32 v127, 7, v127
    v_lshl_add_u32 v127, v129, 3, v127
    v_mad_u32_u24 v110, v127, s12, v128
    v_add_u32 v126, 448, v1
    v_mul_u32_u24 v127, 6554, v126
    v_lshrrev_b32 v127, 16, v127
    v_mul_u32_u24 v128, 10, v127
    v_sub_u32 v128, v126, v128
    v_lshlrev_b32 v128, 4, v128
    v_lshrrev_b32 v129, 4, v127
    v_add_u32 v129, s13, v129
    v_and_b32 v130, 1, v129
    v_lshrrev_b32 v129, 1, v129
    v_lshlrev_b32 v129, 2, v129
    v_add_u32 v129, v129, v130
    v_bfe_u32 v130, v127, 3, 1
    v_lshl_add_u32 v129, v130, 1, v129
    v_and_b32 v127, 7, v127
    v_lshl_add_u32 v127, v129, 3, v127
    v_mad_u32_u24 v111, v127, s12, v128
    s_setprio 2
    s_waitcnt lgkmcnt(0)
    s_mul_i32 s10, s10, 0x9E3779B1
    s_add_u32 s10, s10, 0x7F4A7C15
    s_waitcnt vmcnt(0)
    s_add_u32 m0, s70, 16384
    s_nop 0
    buffer_load_dwordx4 v7, s[48:51], s73 offen offset:2048 lds
    buffer_load_dwordx4 v2, s[48:51], s73 offen offset:3072 lds
    s_add_u32 s73, s73, 128
    s_lshl_b32 s11, s96, 7
    s_add_u32 s73, s73, s11
    s_add_u32 m0, s69, 24576
    s_nop 0
    buffer_load_dwordx4 v4, s[52:55], s71 offen offset:0 lds
    buffer_load_dwordx4 v5, s[52:55], s71 offen offset:1024 lds
    buffer_load_dwordx4 v6, s[52:55], s71 offen offset:2048 lds
    s_add_u32 s71, s71, 98304
    s_add_u32 m0, s69, 36864
    s_nop 0
    buffer_load_dwordx4 v4, s[52:55], s71 offen offset:0 lds
    buffer_load_dwordx4 v5, s[52:55], s71 offen offset:1024 lds
    buffer_load_dwordx4 v6, s[52:55], s71 offen offset:2048 lds
    s_add_u32 s71, s71, 98304
    s_mul_i32 s11, s96, 196608
    s_add_u32 s71, s71, s11
    s_add_u32 m0, s70, 32768
    s_nop 0
    buffer_load_dwordx4 v7, s[48:51], s72 offen offset:0 lds
    buffer_load_dwordx4 v2, s[48:51], s72 offen offset:1024 lds
    s_add_u32 s72, s72, 128
    s_add_u32 s97, s97, 1
    s_cmp_eq_u32 s97, 10
    s_cselect_b32 s11, 1024, 0
    s_sub_u32 s72, s72, s11
    s_add_u32 m0, s70, 32768
    s_nop 0
    buffer_load_dwordx4 v7, s[48:51], s73 offen offset:2048 lds
    buffer_load_dwordx4 v2, s[48:51], s73 offen offset:3072 lds
    s_add_u32 s73, s73, 128
    s_add_u32 s98, s98, 1
    s_cmp_eq_u32 s98, 10
    s_cselect_b32 s11, 1024, 0
    s_sub_u32 s73, s73, s11
    s_add_u32 m0, s69, 49152
    s_nop 0
    buffer_load_dwordx4 v4, s[52:55], s71 offen offset:0 lds
    buffer_load_dwordx4 v5, s[52:55], s71 offen offset:1024 lds
    buffer_load_dwordx4 v6, s[52:55], s71 offen offset:2048 lds
    s_add_u32 s71, s71, 98304
    s_add_u32 s99, s99, 1
    s_cmp_eq_u32 s99, 20
    s_cselect_b32 s11, 1572864, 0
    s_sub_u32 s71, s71, s11
    s_waitcnt lgkmcnt(0)
    s_barrier
    v_add_u32 v139, s93, v137
    s_add_u32 s93, s93, 128
    s_cmp_eq_u32 s93, 1280
    s_cselect_b32 s93, 256, s93
    ds_read_b128 v[144:147], v136 offset:0
    ds_read_b128 v[148:151], v139 offset:0
    ds_read_b128 v[152:155], v138 offset:0
    ds_read_b128 v[156:159], v139 offset:64
    s_waitcnt vmcnt(19)
    s_barrier
    s_add_u32 m0, s69, 61440
    s_nop 0
    buffer_load_dwordx4 v4, s[52:55], s71 offen offset:0 lds
    buffer_load_dwordx4 v5, s[52:55], s71 offen offset:1024 lds
    buffer_load_dwordx4 v6, s[52:55], s71 offen offset:2048 lds
    s_add_u32 s71, s71, 98304
    s_add_u32 s99, s99, 1
    s_cmp_eq_u32 s99, 20
    s_cselect_b32 s11, 1572864, 0
    s_sub_u32 s71, s71, s11
    s_add_u32 m0, s70, 49152
    s_nop 0
    buffer_load_dwordx4 v7, s[48:51], s72 offen offset:0 lds
    buffer_load_dwordx4 v2, s[48:51], s72 offen offset:1024 lds
    s_add_u32 s72, s72, 128
    s_add_u32 s97, s97, 1
    s_cmp_eq_u32 s97, 10
    s_cselect_b32 s11, 1024, 0
    s_sub_u32 s72, s72, s11
    s_waitcnt lgkmcnt(0)
    v_mfma_f32_16x16x32_bf16 v[140:143], v[148:151], v[144:147], v[140:143]
    v_mfma_f32_16x16x32_bf16 v[140:143], v[156:159], v[152:155], v[140:143]
    s_waitcnt vmcnt(15)
    s_barrier
    s_add_u32 m0, s70, 49152
    s_nop 0
    buffer_load_dwordx4 v7, s[48:51], s73 offen offset:2048 lds
    buffer_load_dwordx4 v2, s[48:51], s73 offen offset:3072 lds
    s_add_u32 s73, s73, 128
    s_add_u32 s98, s98, 1
    s_cmp_eq_u32 s98, 10
    s_cselect_b32 s11, 1024, 0
    s_sub_u32 s73, s73, s11
    s_add_u32 m0, s69, 0
    s_nop 0
    buffer_load_dwordx4 v4, s[52:55], s71 offen offset:0 lds
    buffer_load_dwordx4 v5, s[52:55], s71 offen offset:1024 lds
    buffer_load_dwordx4 v6, s[52:55], s71 offen offset:2048 lds
    s_add_u32 s71, s71, 98304
    s_add_u32 s99, s99, 1
    s_cmp_eq_u32 s99, 20
    s_cselect_b32 s11, 1572864, 0
    s_sub_u32 s71, s71, s11
    v_add_u32 v139, s93, v137
    s_add_u32 s93, s93, 128
    s_lshl_b32 s11, s96, 7
    s_add_u32 s93, s93, s11
    s_cmp_eq_u32 s93, 1280
    s_cselect_b32 s93, 256, s93
    ds_read_b128 v[144:147], v136 offset:16384
    ds_read_b128 v[148:151], v139 offset:0
    ds_read_b128 v[152:155], v138 offset:16384
    ds_read_b128 v[156:159], v139 offset:64
    s_waitcnt vmcnt(17)
    s_barrier
    s_add_u32 m0, s69, 12288
    s_nop 0
    buffer_load_dwordx4 v4, s[52:55], s71 offen offset:0 lds
    buffer_load_dwordx4 v5, s[52:55], s71 offen offset:1024 lds
    buffer_load_dwordx4 v6, s[52:55], s71 offen offset:2048 lds
    s_add_u32 s71, s71, 98304
    s_add_u32 s99, s99, 1
    s_cmp_eq_u32 s99, 20
    s_cselect_b32 s11, 1572864, 0
    s_sub_u32 s71, s71, s11
    s_add_u32 m0, s70, 0
    s_nop 0
    buffer_load_dwordx4 v7, s[48:51], s72 offen offset:0 lds
    buffer_load_dwordx4 v2, s[48:51], s72 offen offset:1024 lds
    s_add_u32 s72, s72, 128
    s_add_u32 s97, s97, 1
    s_cmp_eq_u32 s97, 10
    s_cselect_b32 s11, 1024, 0
    s_sub_u32 s72, s72, s11
    s_waitcnt lgkmcnt(0)
    v_mfma_f32_16x16x32_bf16 v[140:143], v[148:151], v[144:147], v[140:143]
    v_mfma_f32_16x16x32_bf16 v[140:143], v[156:159], v[152:155], v[140:143]
    s_waitcnt vmcnt(15)
    s_barrier
    s_add_u32 m0, s70, 0
    s_nop 0
    buffer_load_dwordx4 v7, s[48:51], s73 offen offset:2048 lds
    buffer_load_dwordx4 v2, s[48:51], s73 offen offset:3072 lds
    s_add_u32 s73, s73, 128
    s_add_u32 s98, s98, 1
    s_cmp_eq_u32 s98, 10
    s_cselect_b32 s11, 1024, 0
    s_sub_u32 s73, s73, s11
    s_add_u32 m0, s69, 24576
    s_nop 0
    buffer_load_dwordx4 v4, s[52:55], s71 offen offset:0 lds
    buffer_load_dwordx4 v5, s[52:55], s71 offen offset:1024 lds
    buffer_load_dwordx4 v6, s[52:55], s71 offen offset:2048 lds
    s_add_u32 s71, s71, 98304
    s_add_u32 s99, s99, 1
    s_cmp_eq_u32 s99, 20
    s_cselect_b32 s11, 1572864, 0
    s_sub_u32 s71, s71, s11
    v_add_u32 v139, s93, v137
    s_add_u32 s93, s93, 128
    s_cmp_eq_u32 s93, 1280
    s_cselect_b32 s93, 256, s93
    ds_read_b128 v[144:147], v136 offset:32768
    ds_read_b128 v[148:151], v139 offset:0
    ds_read_b128 v[152:155], v138 offset:32768
    ds_read_b128 v[156:159], v139 offset:64
    s_waitcnt vmcnt(17)
    s_barrier
    s_add_u32 m0, s69, 36864
    s_nop 0
    buffer_load_dwordx4 v4, s[52:55], s71 offen offset:0 lds
    buffer_load_dwordx4 v5, s[52:55], s71 offen offset:1024 lds
    buffer_load_dwordx4 v6, s[52:55], s71 offen offset:2048 lds
    s_add_u32 s71, s71, 98304
    s_add_u32 s99, s99, 1
    s_cmp_eq_u32 s99, 20
    s_cselect_b32 s11, 1572864, 0
    s_sub_u32 s71, s71, s11
    s_add_u32 m0, s70, 16384
    s_nop 0
    buffer_load_dwordx4 v7, s[48:51], s72 offen offset:0 lds
    buffer_load_dwordx4 v2, s[48:51], s72 offen offset:1024 lds
    s_add_u32 s72, s72, 128
    s_add_u32 s97, s97, 1
    s_cmp_eq_u32 s97, 10
    s_cselect_b32 s11, 1024, 0
    s_sub_u32 s72, s72, s11
    s_waitcnt lgkmcnt(0)
    v_mfma_f32_16x16x32_bf16 v[140:143], v[148:151], v[144:147], v[140:143]
    v_mfma_f32_16x16x32_bf16 v[140:143], v[156:159], v[152:155], v[140:143]
    v_mov_b32 v160, s10
    v_mov_b32 v161, 0
    s_mov_b64 exec, 1
    buffer_store_dword v160, v161, s[44:47], s78 offen sc1
    s_mov_b64 exec, -1
    s_waitcnt vmcnt(16)
    s_barrier
    s_add_u32 m0, s70, 16384
    s_nop 0
    buffer_load_dwordx4 v7, s[48:51], s73 offen offset:2048 lds
    buffer_load_dwordx4 v2, s[48:51], s73 offen offset:3072 lds
    s_add_u32 s73, s73, 128
    s_add_u32 s98, s98, 1
    s_cmp_eq_u32 s98, 10
    s_cselect_b32 s11, 1024, 0
    s_sub_u32 s73, s73, s11
    s_add_u32 m0, s69, 49152
    s_nop 0
    buffer_load_dwordx4 v4, s[52:55], s71 offen offset:0 lds
    buffer_load_dwordx4 v5, s[52:55], s71 offen offset:1024 lds
    buffer_load_dwordx4 v6, s[52:55], s71 offen offset:2048 lds
    s_add_u32 s71, s71, 98304
    s_add_u32 s99, s99, 1
    s_cmp_eq_u32 s99, 20
    s_cselect_b32 s11, 1572864, 0
    s_sub_u32 s71, s71, s11
    v_add_u32 v139, s93, v137
    s_add_u32 s93, s93, 128
    s_cmp_eq_u32 s93, 1280
    s_cselect_b32 s93, 256, s93
    ds_read_b128 v[144:147], v136 offset:49152
    ds_read_b128 v[148:151], v139 offset:0
    ds_read_b128 v[152:155], v138 offset:49152
    ds_read_b128 v[156:159], v139 offset:64
    s_waitcnt vmcnt(18)
    s_barrier
    s_add_u32 m0, s69, 61440
    s_nop 0
    buffer_load_dwordx4 v4, s[52:55], s71 offen offset:0 lds
    buffer_load_dwordx4 v5, s[52:55], s71 offen offset:1024 lds
    buffer_load_dwordx4 v6, s[52:55], s71 offen offset:2048 lds
    s_add_u32 s71, s71, 98304
    s_add_u32 s99, s99, 1
    s_cmp_eq_u32 s99, 20
    s_cselect_b32 s11, 1572864, 0
    s_sub_u32 s71, s71, s11
    s_add_u32 m0, s70, 32768
    s_nop 0
    buffer_load_dwordx4 v7, s[48:51], s72 offen offset:0 lds
    buffer_load_dwordx4 v2, s[48:51], s72 offen offset:1024 lds
    s_add_u32 s72, s72, 128
    s_add_u32 s97, s97, 1
    s_cmp_eq_u32 s97, 10
    s_cselect_b32 s11, 1024, 0
    s_sub_u32 s72, s72, s11
    s_waitcnt lgkmcnt(0)
    v_mfma_f32_16x16x32_bf16 v[140:143], v[148:151], v[144:147], v[140:143]
    v_mfma_f32_16x16x32_bf16 v[140:143], v[156:159], v[152:155], v[140:143]
    s_mov_b32 m0, 150784
    s_nop 0
    buffer_load_dwordx4 v104, s[56:59], s91 offen  lds
    s_add_u32 m0, m0, 1024
    s_nop 0
    buffer_load_dwordx4 v105, s[56:59], s91 offen  lds
    s_add_u32 m0, m0, 1024
    s_nop 0
    buffer_load_dwordx4 v106, s[56:59], s91 offen  lds
    s_add_u32 m0, m0, 1024
    s_nop 0
    buffer_load_dwordx4 v107, s[56:59], s91 offen  lds
    s_add_u32 m0, m0, 1024
    s_nop 0
    buffer_load_dwordx4 v108, s[56:59], s91 offen  lds
    s_add_u32 m0, m0, 1024
    s_nop 0
    buffer_load_dwordx4 v109, s[56:59], s91 offen  lds
    s_add_u32 m0, m0, 1024
    s_nop 0
    buffer_load_dwordx4 v110, s[56:59], s91 offen  lds
    s_add_u32 m0, m0, 1024
    s_nop 0
    s_mov_b32 exec_hi, 0
    buffer_load_dwordx4 v111, s[56:59], s91 offen  lds
    s_mov_b32 exec_hi, -1
    s_waitcnt vmcnt(24)
    s_barrier
    s_add_u32 m0, s70, 32768
    s_nop 0
    buffer_load_dwordx4 v7, s[48:51], s73 offen offset:2048 lds
    buffer_load_dwordx4 v2, s[48:51], s73 offen offset:3072 lds
    s_add_u32 s73, s73, 128
    s_add_u32 s98, s98, 1
    s_cmp_eq_u32 s98, 10
    s_cselect_b32 s11, 1024, 0
    s_sub_u32 s73, s73, s11
    s_add_u32 m0, s69, 0
    s_nop 0
    buffer_load_dwordx4 v4, s[52:55], s71 offen offset:0 lds
    buffer_load_dwordx4 v5, s[52:55], s71 offen offset:1024 lds
    buffer_load_dwordx4 v6, s[52:55], s71 offen offset:2048 lds
    s_add_u32 s71, s71, 98304
    s_add_u32 s99, s99, 1
    s_cmp_eq_u32 s99, 20
    s_cselect_b32 s11, 1572864, 0
    s_sub_u32 s71, s71, s11
    v_add_u32 v139, s93, v137
    s_add_u32 s93, s93, 128
    s_cmp_eq_u32 s93, 1280
    s_cselect_b32 s93, 256, s93
    ds_read_b128 v[144:147], v136 offset:0
    ds_read_b128 v[148:151], v139 offset:0
    ds_read_b128 v[152:155], v138 offset:0
    ds_read_b128 v[156:159], v139 offset:64
    s_waitcnt vmcnt(26)
    s_barrier
    s_add_u32 m0, s69, 12288
    s_nop 0
    buffer_load_dwordx4 v4, s[52:55], s71 offen offset:0 lds
    buffer_load_dwordx4 v5, s[52:55], s71 offen offset:1024 lds
    buffer_load_dwordx4 v6, s[52:55], s71 offen offset:2048 lds
    s_add_u32 s71, s71, 98304
    s_add_u32 s99, s99, 1
    s_cmp_eq_u32 s99, 20
    s_cselect_b32 s11, 1572864, 0
    s_sub_u32 s71, s71, s11
    s_add_u32 m0, s70, 49152
    s_nop 0
    buffer_load_dwordx4 v7, s[48:51], s72 offen offset:0 lds
    buffer_load_dwordx4 v2, s[48:51], s72 offen offset:1024 lds
    s_add_u32 s72, s72, 128
    s_add_u32 s97, s97, 1
    s_cmp_eq_u32 s97, 10
    s_cselect_b32 s11, 1024, 0
    s_sub_u32 s72, s72, s11
    s_waitcnt lgkmcnt(0)
    v_mfma_f32_16x16x32_bf16 v[140:143], v[148:151], v[144:147], v[140:143]
    v_mfma_f32_16x16x32_bf16 v[140:143], v[156:159], v[152:155], v[140:143]
    s_waitcnt vmcnt(23)
    s_barrier
    s_add_u32 m0, s70, 49152
    s_nop 0
    buffer_load_dwordx4 v7, s[48:51], s73 offen offset:2048 lds
    buffer_load_dwordx4 v2, s[48:51], s73 offen offset:3072 lds
    s_add_u32 s73, s73, 128
    s_add_u32 s98, s98, 1
    s_cmp_eq_u32 s98, 10
    s_cselect_b32 s11, 1024, 0
    s_sub_u32 s73, s73, s11
    s_add_u32 m0, s69, 24576
    s_nop 0
    buffer_load_dwordx4 v4, s[52:55], s71 offen offset:0 lds
    buffer_load_dwordx4 v5, s[52:55], s71 offen offset:1024 lds
    buffer_load_dwordx4 v6, s[52:55], s71 offen offset:2048 lds
    s_add_u32 s71, s71, 98304
    s_add_u32 s99, s99, 1
    s_cmp_eq_u32 s99, 20
    s_cselect_b32 s11, 1572864, 0
    s_sub_u32 s71, s71, s11
    v_add_u32 v139, s93, v137
    s_add_u32 s93, s93, 128
    s_cmp_eq_u32 s93, 1280
    s_cselect_b32 s93, 256, s93
    ds_read_b128 v[144:147], v136 offset:16384
    ds_read_b128 v[148:151], v139 offset:0
    ds_read_b128 v[152:155], v138 offset:16384
    ds_read_b128 v[156:159], v139 offset:64
    s_waitcnt vmcnt(15)
    ds_read_b64_tr_b16 v[64:65], v116 offset:0
    ds_read_b64_tr_b16 v[66:67], v116 offset:1280
    ds_read_b64_tr_b16 v[68:69], v116 offset:64
    ds_read_b64_tr_b16 v[70:71], v116 offset:1344
    ds_read_b64_tr_b16 v[72:73], v116 offset:128
    ds_read_b64_tr_b16 v[74:75], v116 offset:1408
    ds_read_b64_tr_b16 v[76:77], v116 offset:2560
    ds_read_b64_tr_b16 v[78:79], v116 offset:3840
    ds_read_b64_tr_b16 v[80:81], v116 offset:2624
    ds_read_b64_tr_b16 v[82:83], v116 offset:3904
    ds_read_b64_tr_b16 v[84:85], v116 offset:2688
    ds_read_b64_tr_b16 v[86:87], v116 offset:3968
    ds_read_b64_tr_b16 v[88:89], v116 offset:5120
    ds_read_b64_tr_b16 v[90:91], v116 offset:6400
    ds_read_b64_tr_b16 v[92:93], v116 offset:5184
    ds_read_b64_tr_b16 v[94:95], v116 offset:6464
    ds_read_b64_tr_b16 v[96:97], v116 offset:5248
    ds_read_b64_tr_b16 v[98:99], v116 offset:6528
    s_mul_i32 s13, s8, 3
    s_mul_i32 s14, s9, 48
    s_add_u32 s11, s13, 0
    s_lshr_b32 s12, s11, 1
    s_add_u32 s12, s12, s14
    s_mul_i32 s12, s12, 5120
    s_and_b32 s11, s11, 1
    s_lshl_b32 s11, s11, 9
    s_add_u32 s11, s11, s12
    s_add_u32 s11, s11, 4194304
    s_add_u32 s12, s11, 4096
    s_waitcnt lgkmcnt(0)
    buffer_store_dwordx4 v[64:67], v112, s[44:47], s11 offen offset:0 sc1
    buffer_store_dwordx4 v[68:71], v112, s[44:47], s11 offen offset:2048 sc1
    buffer_store_dwordx4 v[72:75], v113, s[44:47], s12 offen sc1
    s_mul_i32 s13, s8, 3
    s_mul_i32 s14, s9, 48
    s_add_u32 s11, s13, 1
    s_lshr_b32 s12, s11, 1
    s_add_u32 s12, s12, s14
    s_mul_i32 s12, s12, 5120
    s_and_b32 s11, s11, 1
    s_lshl_b32 s11, s11, 9
    s_add_u32 s11, s11, s12
    s_add_u32 s11, s11, 4194304
    s_add_u32 s12, s11, 4096
    s_waitcnt lgkmcnt(0)
    buffer_store_dwordx4 v[76:79], v112, s[44:47], s11 offen offset:0 sc1
    buffer_store_dwordx4 v[80:83], v112, s[44:47], s11 offen offset:2048 sc1
    buffer_store_dwordx4 v[84:87], v113, s[44:47], s12 offen sc1
    s_mul_i32 s13, s8, 3
    s_mul_i32 s14, s9, 48
    s_add_u32 s11, s13, 2
    s_lshr_b32 s12, s11, 1
    s_add_u32 s12, s12, s14
    s_mul_i32 s12, s12, 5120
    s_and_b32 s11, s11, 1
    s_lshl_b32 s11, s11, 9
    s_add_u32 s11, s11, s12
    s_add_u32 s11, s11, 4194304
    s_add_u32 s12, s11, 4096
    s_waitcnt lgkmcnt(0)
    buffer_store_dwordx4 v[88:91], v112, s[44:47], s11 offen offset:0 sc1
    buffer_store_dwordx4 v[92:95], v112, s[44:47], s11 offen offset:2048 sc1
    buffer_store_dwordx4 v[96:99], v113, s[44:47], s12 offen sc1
    s_waitcnt vmcnt(34)
    s_barrier
    s_add_u32 m0, s69, 36864
    s_nop 0
    buffer_load_dwordx4 v4, s[52:55], s71 offen offset:0 lds
    buffer_load_dwordx4 v5, s[52:55], s71 offen offset:1024 lds
    buffer_load_dwordx4 v6, s[52:55], s71 offen offset:2048 lds
    s_add_u32 s71, s71, 98304
    s_add_u32 s99, s99, 1
    s_cmp_eq_u32 s99, 20
    s_cselect_b32 s11, 1572864, 0
    s_sub_u32 s71, s71, s11
    s_add_u32 m0, s70, 0
    s_nop 0
    buffer_load_dwordx4 v7, s[48:51], s72 offen offset:0 lds
    buffer_load_dwordx4 v2, s[48:51], s72 offen offset:1024 lds
    s_add_u32 s72, s72, 128
    s_add_u32 s97, s97, 1
    s_cmp_eq_u32 s97, 10
    s_cselect_b32 s11, 1024, 0
    s_sub_u32 s72, s72, s11
    s_waitcnt lgkmcnt(0)
    v_mfma_f32_16x16x32_bf16 v[140:143], v[148:151], v[144:147], v[140:143]
    v_mfma_f32_16x16x32_bf16 v[140:143], v[156:159], v[152:155], v[140:143]
    s_waitcnt vmcnt(24)
    s_barrier
    s_add_u32 m0, s70, 0
    s_nop 0
    buffer_load_dwordx4 v7, s[48:51], s73 offen offset:2048 lds
    buffer_load_dwordx4 v2, s[48:51], s73 offen offset:3072 lds
    s_add_u32 s73, s73, 128
    s_add_u32 s98, s98, 1
    s_cmp_eq_u32 s98, 10
    s_cselect_b32 s11, 1024, 0
    s_sub_u32 s73, s73, s11
    s_add_u32 m0, s69, 49152
    s_nop 0
    buffer_load_dwordx4 v4, s[52:55], s71 offen offset:0 lds
    buffer_load_dwordx4 v5, s[52:55], s71 offen offset:1024 lds
    buffer_load_dwordx4 v6, s[52:55], s71 offen offset:2048 lds
    s_add_u32 s71, s71, 98304
    s_add_u32 s99, s99, 1
    s_cmp_eq_u32 s99, 20
    s_cselect_b32 s11, 1572864, 0
    s_sub_u32 s71, s71, s11
    v_add_u32 v139, s93, v137
    s_add_u32 s93, s93, 128
    s_cmp_eq_u32 s93, 1280
    s_cselect_b32 s93, 256, s93
    ds_read_b128 v[144:147], v136 offset:32768
    ds_read_b128 v[148:151], v139 offset:0
    ds_read_b128 v[152:155], v138 offset:32768
    ds_read_b128 v[156:159], v139 offset:64
    s_waitcnt vmcnt(26)
    s_barrier
    s_add_u32 m0, s69, 61440
    s_nop 0
    buffer_load_dwordx4 v4, s[52:55], s71 offen offset:0 lds
    buffer_load_dwordx4 v5, s[52:55], s71 offen offset:1024 lds
    buffer_load_dwordx4 v6, s[52:55], s71 offen offset:2048 lds
    s_add_u32 s71, s71, 98304
    s_add_u32 s99, s99, 1
    s_cmp_eq_u32 s99, 20
    s_cselect_b32 s11, 1572864, 0
    s_sub_u32 s71, s71, s11
    s_add_u32 m0, s70, 16384
    s_nop 0
    buffer_load_dwordx4 v7, s[48:51], s72 offen offset:0 lds
    buffer_load_dwordx4 v2, s[48:51], s72 offen offset:1024 lds
    s_add_u32 s72, s72, 128
    s_add_u32 s97, s97, 1
    s_cmp_eq_u32 s97, 10
    s_cselect_b32 s11, 1024, 0
    s_sub_u32 s72, s72, s11
    s_waitcnt lgkmcnt(0)
    v_mfma_f32_16x16x32_bf16 v[140:143], v[148:151], v[144:147], v[140:143]
    v_mfma_f32_16x16x32_bf16 v[140:143], v[156:159], v[152:155], v[140:143]
    v_lshlrev_b32 v18, 3, v1
    s_lshl_b32 s90, s9, 9
    s_add_u32 s90, s90, 4096
    buffer_load_dwordx2 v[20:21], v18, s[44:47], s90 offen sc1
    s_waitcnt vmcnt(25)
    s_barrier
    s_add_u32 m0, s70, 16384
    s_nop 0
    buffer_load_dwordx4 v7, s[48:51], s73 offen offset:2048 lds
    buffer_load_dwordx4 v2, s[48:51], s73 offen offset:3072 lds
    s_add_u32 s73, s73, 128
    s_add_u32 s98, s98, 1
    s_cmp_eq_u32 s98, 10
    s_cselect_b32 s11, 1024, 0
    s_sub_u32 s73, s73, s11
    s_add_u32 m0, s69, 0
    s_nop 0
    buffer_load_dwordx4 v4, s[52:55], s71 offen offset:0 lds
    buffer_load_dwordx4 v5, s[52:55], s71 offen offset:1024 lds
    buffer_load_dwordx4 v6, s[52:55], s71 offen offset:2048 lds
    s_add_u32 s71, s71, 98304
    s_add_u32 s99, s99, 1
    s_cmp_eq_u32 s99, 20
    s_cselect_b32 s11, 1572864, 0
    s_sub_u32 s71, s71, s11
    v_add_u32 v139, s93, v137
    s_add_u32 s93, s93, 128
    s_cmp_eq_u32 s93, 1280
    s_cselect_b32 s93, 256, s93
    ds_read_b128 v[144:147], v136 offset:49152
    ds_read_b128 v[148:151], v139 offset:0
    ds_read_b128 v[152:155], v138 offset:49152
    ds_read_b128 v[156:159], v139 offset:64
    s_lshl_b32 s11, s9, 5
    s_add_u32 s11, s11, s8
    s_lshl_b32 s11, s11, 2
    s_add_u32 s92, s11, 20480
    s_waitcnt vmcnt(21)
    v_mov_b32 v160, s10
    v_mov_b32 v161, 0
    s_mov_b64 exec, 1
    buffer_store_dword v160, v161, s[44:47], s92 offen sc1
    s_mov_b64 exec, -1
    s_waitcnt vmcnt(19)
    s_barrier
    s_add_u32 m0, s69, 12288
    s_nop 0
    buffer_load_dwordx4 v4, s[52:55], s71 offen offset:0 lds
    buffer_load_dwordx4 v5, s[52:55], s71 offen offset:1024 lds
    buffer_load_dwordx4 v6, s[52:55], s71 offen offset:2048 lds
    s_add_u32 s71, s71, 98304
    s_add_u32 s99, s99, 1
    s_cmp_eq_u32 s99, 20
    s_cselect_b32 s11, 1572864, 0
    s_sub_u32 s71, s71, s11
    s_waitcnt lgkmcnt(0)
    v_mfma_f32_16x16x32_bf16 v[140:143], v[148:151], v[144:147], v[140:143]
    v_mfma_f32_16x16x32_bf16 v[140:143], v[156:159], v[152:155], v[140:143]
    s_waitcnt vmcnt(15)
    s_barrier
    v_add_u32 v139, s93, v137
    s_add_u32 s93, s93, 128
    s_cmp_eq_u32 s93, 1280
    s_cselect_b32 s93, 256, s93
    ds_read_b128 v[144:147], v136 offset:0
    ds_read_b128 v[148:151], v139 offset:0
    ds_read_b128 v[152:155], v138 offset:0
    ds_read_b128 v[156:159], v139 offset:64
    s_waitcnt vmcnt(9)
    v_xor_b32 v20, s10, v20
    v_xor_b32 v21, s10, v21
    v_or_b32 v20, v20, v21
    v_cmp_ne_u32 vcc, 0, v20
    s_mov_b32 s94, 0
    s_cmp_eq_u64 vcc, 0
    s_cbranch_scc0 L_chk_no
    s_mov_b32 s94, 1
    v_mov_b32 v12, 1
    s_mov_b64 exec, 1
    ds_write_b32 v0, v12 offset:32
    s_mov_b64 exec, -1
L_chk_no:
    v_lshlrev_b32 v16, 4, v1
    v_add_u32 v17, 4096, v16
    s_mul_i32 s95, s9, 245760
    s_add_u32 s95, s95, 4194304
    s_waitcnt vmcnt(12)
    s_barrier
    s_waitcnt lgkmcnt(0)
    v_mfma_f32_16x16x32_bf16 v[140:143], v[148:151], v[144:147], v[140:143]
    v_mfma_f32_16x16x32_bf16 v[140:143], v[156:159], v[152:155], v[140:143]
    s_waitcnt vmcnt(4)
    s_barrier
    v_add_u32 v139, s93, v137
    s_add_u32 s93, s93, 128
    s_cmp_eq_u32 s93, 1280
    s_cselect_b32 s93, 256, s93
    ds_read_b128 v[144:147], v136 offset:16384
    ds_read_b128 v[148:151], v139 offset:0
    ds_read_b128 v[152:155], v138 offset:16384
    ds_read_b128 v[156:159], v139 offset:64
    v_and_b32 v8, 31, v1
    v_lshlrev_b32 v8, 2, v8
    s_lshl_b32 s79, s9, 7
    s_add_u32 s79, s79, 20480
    buffer_load_dword v10, v8, s[44:47], s79 offen sc1
    s_waitcnt vmcnt(1)
    s_barrier
    s_waitcnt lgkmcnt(0)
    v_mfma_f32_16x16x32_bf16 v[140:143], v[148:151], v[144:147], v[140:143]
    v_mfma_f32_16x16x32_bf16 v[140:143], v[156:159], v[152:155], v[140:143]
    s_lshl_b32 s11, s6, 9
    s_lshr_b32 s12, s7, 1
    s_lshl_b32 s12, s12, 6
    s_add_u32 s11, s11, s12
    s_add_u32 s11, s11, 32768
    s_and_b32 s12, s7, 1
    s_lshl_b32 s12, s12, 3
    s_lshl_b32 s12, 0xff, s12
    s_nop 0
    v_cvt_pk_bf16_f32 v140, v140, v140
    v_lshlrev_b32 v140, 16, v140
    v_mul_f32 v140, 0xbfb8aa3b, v140
    v_exp_f32 v140, v140
    s_nop 0
    v_add_f32 v140, 1.0, v140
    v_rcp_f32 v140, v140
    s_nop 0
    v_cvt_pk_bf16_f32 v140, v140, v140
    v_lshlrev_b32 v140, 16, v140
    v_sub_f32 v141, 1.0, v140
    v_cvt_pk_bf16_f32 v140, v140, v141
    v_lshlrev_b32 v141, 2, v1
    s_mov_b32 exec_lo, s12
    s_mov_b32 exec_hi, 0
    buffer_store_dword v140, v141, s[44:47], s11 offen sc1
    s_mov_b64 exec, -1
    s_barrier
    s_barrier
    s_cmp_lg_u32 s94, 0
    s_cbranch_scc1 L_svc_ok
    s_mov_b32 s12, 65536
    s_branch L_spin2_ld
L_spin2:
    s_sleep 14
L_spin2_ld:
    buffer_load_dwordx2 v[20:21], v18, s[44:47], s90 offen sc1
    s_waitcnt vmcnt(0)
L_spin2_chk:
    v_xor_b32 v20, s10, v20
    v_xor_b32 v21, s10, v21
    v_or_b32 v20, v20, v21
    v_cmp_ne_u32 vcc, 0, v20
    s_sub_u32 s12, s12, 1
    s_cselect_b64 vcc, 0, vcc
    s_cmp_eq_u64 vcc, 0
    s_cbranch_scc0 L_spin2
    v_mov_b32 v12, 1
    s_mov_b64 exec, 1
    ds_write_b32 v0, v12 offset:32
    s_mov_b64 exec, -1
L_svc_ok:
    s_mov_b32 s12, 65536
    s_waitcnt vmcnt(1)
    s_branch L_spin3_chk
L_spin3:
    s_sleep 14
L_spin3_ld:
    buffer_load_dword v10, v8, s[44:47], s79 offen sc1
    s_waitcnt vmcnt(0)
L_spin3_chk:
    v_cmp_ne_u32 vcc, s10, v10
    s_sub_u32 s12, s12, 1
    s_cselect_b64 vcc, 0, vcc
    s_cmp_eq_u64 vcc, 0
    s_cbranch_scc0 L_spin3
    v_mov_b32 v12, 1
    s_mov_b64 exec, 1
    ds_write_b32 v0, v12 offset:4
    s_mov_b64 exec, -1
    v_mov_b32 v12, 16
    s_mov_b64 exec, 1
    ds_add_u32 v0, v12 offset:40
    s_mov_b64 exec, -1
    s_add_u32 s13, s95, 25600
    s_mov_b32 m0, 24576
    s_nop 0
    buffer_load_dwordx4 v16, s[44:47], s13 offen offset:0 sc1 lds
    buffer_load_dwordx4 v16, s[44:47], s13 offen offset:1024 sc1 lds
    buffer_load_dwordx4 v16, s[44:47], s13 offen offset:2048 sc1 lds
    buffer_load_dwordx4 v16, s[44:47], s13 offen offset:3072 sc1 lds
    s_mov_b32 m0, 28672
    s_nop 0
    buffer_load_dwordx4 v17, s[44:47], s13 offen sc1 lds
    s_add_u32 s13, s95, 87040
    s_mov_b32 m0, 29696
    s_nop 0
    buffer_load_dwordx4 v16, s[44:47], s13 offen offset:0 sc1 lds
    buffer_load_dwordx4 v16, s[44:47], s13 offen offset:1024 sc1 lds
    buffer_load_dwordx4 v16, s[44:47], s13 offen offset:2048 sc1 lds
    buffer_load_dwordx4 v16, s[44:47], s13 offen offset:3072 sc1 lds
    s_mov_b32 m0, 33792
    s_nop 0
    buffer_load_dwordx4 v17, s[44:47], s13 offen sc1 lds
    s_add_u32 s13, s95, 148480
    s_mov_b32 m0, 34816
    s_nop 0
    buffer_load_dwordx4 v16, s[44:47], s13 offen offset:0 sc1 lds
    buffer_load_dwordx4 v16, s[44:47], s13 offen offset:1024 sc1 lds
    buffer_load_dwordx4 v16, s[44:47], s13 offen offset:2048 sc1 lds
    buffer_load_dwordx4 v16, s[44:47], s13 offen offset:3072 sc1 lds
    s_mov_b32 m0, 38912
    s_nop 0
    buffer_load_dwordx4 v17, s[44:47], s13 offen sc1 lds
    s_add_u32 s13, s95, 209920
    s_mov_b32 m0, 39936
    s_nop 0
    buffer_load_dwordx4 v16, s[44:47], s13 offen offset:0 sc1 lds
    buffer_load_dwordx4 v16, s[44:47], s13 offen offset:1024 sc1 lds
    buffer_load_dwordx4 v16, s[44:47], s13 offen offset:2048 sc1 lds
    buffer_load_dwordx4 v16, s[44:47], s13 offen offset:3072 sc1 lds
    s_mov_b32 m0, 44032
    s_nop 0
    buffer_load_dwordx4 v17, s[44:47], s13 offen sc1 lds
    s_waitcnt vmcnt(20)
    v_mov_b32 v12, 1
    s_mov_b64 exec, 1
    ds_add_u32 v0, v12 offset:44
    s_mov_b64 exec, -1
    s_add_u32 s13, s95, 30720
    s_mov_b32 m0, 45056
    s_nop 0
    buffer_load_dwordx4 v16, s[44:47], s13 offen offset:0 sc1 lds
    buffer_load_dwordx4 v16, s[44:47], s13 offen offset:1024 sc1 lds
    buffer_load_dwordx4 v16, s[44:47], s13 offen offset:2048 sc1 lds
    buffer_load_dwordx4 v16, s[44:47], s13 offen offset:3072 sc1 lds
    s_mov_b32 m0, 49152
    s_nop 0
    buffer_load_dwordx4 v17, s[44:47], s13 offen sc1 lds
    s_add_u32 s13, s95, 92160
    s_mov_b32 m0, 50176
    s_nop 0
    buffer_load_dwordx4 v16, s[44:47], s13 offen offset:0 sc1 lds
    buffer_load_dwordx4 v16, s[44:47], s13 offen offset:1024 sc1 lds
    buffer_load_dwordx4 v16, s[44:47], s13 offen offset:2048 sc1 lds
    buffer_load_dwordx4 v16, s[44:47], s13 offen offset:3072 sc1 lds
    s_mov_b32 m0, 54272
    s_nop 0
    buffer_load_dwordx4 v17, s[44:47], s13 offen sc1 lds
    s_add_u32 s13, s95, 153600
    s_mov_b32 m0, 55296
    s_nop 0
    buffer_load_dwordx4 v16, s[44:47], s13 offen offset:0 sc1 lds
    buffer_load_dwordx4 v16, s[44:47], s13 offen offset:1024 sc1 lds
    buffer_load_dwordx4 v16, s[44:47], s13 offen offset:2048 sc1 lds
    buffer_load_dwordx4 v16, s[44:47], s13 offen offset:3072 sc1 lds
    s_mov_b32 m0, 59392
    s_nop 0
    buffer_load_dwordx4 v17, s[44:47], s13 offen sc1 lds
    s_add_u32 s13, s95, 215040
    s_mov_b32 m0, 60416
    s_nop 0
    buffer_load_dwordx4 v16, s[44:47], s13 offen offset:0 sc1 lds
    buffer_load_dwordx4 v16, s[44:47], s13 offen offset:1024 sc1 lds
    buffer_load_dwordx4 v16, s[44:47], s13 offen offset:2048 sc1 lds
    buffer_load_dwordx4 v16, s[44:47], s13 offen offset:3072 sc1 lds
    s_mov_b32 m0, 64512
    s_nop 0
    buffer_load_dwordx4 v17, s[44:47], s13 offen sc1 lds
    s_add_u32 s13, s95, 35840
    s_mov_b32 m0, 65536
    s_nop 0
    buffer_load_dwordx4 v16, s[44:47], s13 offen offset:0 sc1 lds
    buffer_load_dwordx4 v16, s[44:47], s13 offen offset:1024 sc1 lds
    buffer_load_dwordx4 v16, s[44:47], s13 offen offset:2048 sc1 lds
    buffer_load_dwordx4 v16, s[44:47], s13 offen offset:3072 sc1 lds
    s_mov_b32 m0, 69632
    s_nop 0
    buffer_load_dwordx4 v17, s[44:47], s13 offen sc1 lds
    s_add_u32 s13, s95, 97280
    s_mov_b32 m0, 70656
    s_nop 0
    buffer_load_dwordx4 v16, s[44:47], s13 offen offset:0 sc1 lds
    buffer_load_dwordx4 v16, s[44:47], s13 offen offset:1024 sc1 lds
    buffer_load_dwordx4 v16, s[44:47], s13 offen offset:2048 sc1 lds
    buffer_load_dwordx4 v16, s[44:47], s13 offen offset:3072 sc1 lds
    s_mov_b32 m0, 74752
    s_nop 0
    buffer_load_dwordx4 v17, s[44:47], s13 offen sc1 lds
    s_add_u32 s13, s95, 158720
    s_mov_b32 m0, 75776
    s_nop 0
    buffer_load_dwordx4 v16, s[44:47], s13 offen offset:0 sc1 lds
    buffer_load_dwordx4 v16, s[44:47], s13 offen offset:1024 sc1 lds
    buffer_load_dwordx4 v16, s[44:47], s13 offen offset:2048 sc1 lds
    buffer_load_dwordx4 v16, s[44:47], s13 offen offset:3072 sc1 lds
    s_mov_b32 m0, 79872
    s_nop 0
    buffer_load_dwordx4 v17, s[44:47], s13 offen sc1 lds
    s_add_u32 s13, s95, 220160
    s_mov_b32 m0, 80896
    s_nop 0
    buffer_load_dwordx4 v16, s[44:47], s13 offen offset:0 sc1 lds
    buffer_load_dwordx4 v16, s[44:47], s13 offen offset:1024 sc1 lds
    buffer_load_dwordx4 v16, s[44:47], s13 offen offset:2048 sc1 lds
    buffer_load_dwordx4 v16, s[44:47], s13 offen offset:3072 sc1 lds
    s_mov_b32 m0, 84992
    s_nop 0
    buffer_load_dwordx4 v17, s[44:47], s13 offen sc1 lds
    s_add_u32 s13, s95, 40960
    s_mov_b32 m0, 86016
    s_nop 0
    buffer_load_dwordx4 v16, s[44:47], s13 offen offset:0 sc1 lds
    buffer_load_dwordx4 v16, s[44:47], s13 offen offset:1024 sc1 lds
    buffer_load_dwordx4 v16, s[44:47], s13 offen offset:2048 sc1 lds
    buffer_load_dwordx4 v16, s[44:47], s13 offen offset:3072 sc1 lds
    s_mov_b32 m0, 90112
    s_nop 0
    buffer_load_dwordx4 v17, s[44:47], s13 offen sc1 lds
    s_add_u32 s13, s95, 102400
    s_mov_b32 m0, 91136
    s_nop 0
    buffer_load_dwordx4 v16, s[44:47], s13 offen offset:0 sc1 lds
    buffer_load_dwordx4 v16, s[44:47], s13 offen offset:1024 sc1 lds
    buffer_load_dwordx4 v16, s[44:47], s13 offen offset:2048 sc1 lds
    buffer_load_dwordx4 v16, s[44:47], s13 offen offset:3072 sc1 lds
    s_mov_b32 m0, 95232
    s_nop 0
    buffer_load_dwordx4 v17, s[44:47], s13 offen sc1 lds
    s_add_u32 s13, s95, 163840
    s_mov_b32 m0, 96256
    s_nop 0
    buffer_load_dwordx4 v16, s[44:47], s13 offen offset:0 sc1 lds
    buffer_load_dwordx4 v16, s[44:47], s13 offen offset:1024 sc1 lds
    buffer_load_dwordx4 v16, s[44:47], s13 offen offset:2048 sc1 lds
    buffer_load_dwordx4 v16, s[44:47], s13 offen offset:3072 sc1 lds
    s_mov_b32 m0, 100352
    s_nop 0
    buffer_load_dwordx4 v17, s[44:47], s13 offen sc1 lds
    s_add_u32 s13, s95, 225280
    s_mov_b32 m0, 101376
    s_nop 0
    buffer_load_dwordx4 v16, s[44:47], s13 offen offset:0 sc1 lds
    buffer_load_dwordx4 v16, s[44:47], s13 offen offset:1024 sc1 lds
    buffer_load_dwordx4 v16, s[44:47], s13 offen offset:2048 sc1 lds
    buffer_load_dwordx4 v16, s[44:47], s13 offen offset:3072 sc1 lds
    s_mov_b32 m0, 105472
    s_nop 0
    buffer_load_dwordx4 v17, s[44:47], s13 offen sc1 lds
    s_add_u32 s13, s95, 46080
    s_mov_b32 m0, 0
    s_nop 0
    buffer_load_dwordx4 v16, s[44:47], s13 offen offset:0 sc1 lds
    buffer_load_dwordx4 v16, s[44:47], s13 offen offset:1024 sc1 lds
    buffer_load_dwordx4 v16, s[44:47], s13 offen offset:2048 sc1 lds
    buffer_load_dwordx4 v16, s[44:47], s13 offen offset:3072 sc1 lds
    s_mov_b32 m0, 4096
    s_nop 0
    buffer_load_dwordx4 v17, s[44:47], s13 offen sc1 lds
    s_add_u32 s13, s95, 107520
    s_mov_b32 m0, 5120
    s_nop 0
    buffer_load_dwordx4 v16, s[44:47], s13 offen offset:0 sc1 lds
    buffer_load_dwordx4 v16, s[44:47], s13 offen offset:1024 sc1 lds
    buffer_load_dwordx4 v16, s[44:47], s13 offen offset:2048 sc1 lds
    buffer_load_dwordx4 v16, s[44:47], s13 offen offset:3072 sc1 lds
    s_mov_b32 m0, 9216
    s_nop 0
    buffer_load_dwordx4 v17, s[44:47], s13 offen sc1 lds
    s_add_u32 s13, s95, 168960
    s_mov_b32 m0, 10240
    s_nop 0
    buffer_load_dwordx4 v16, s[44:47], s13 offen offset:0 sc1 lds
    buffer_load_dwordx4 v16, s[44:47], s13 offen offset:1024 sc1 lds
    buffer_load_dwordx4 v16, s[44:47], s13 offen offset:2048 sc1 lds
    buffer_load_dwordx4 v16, s[44:47], s13 offen offset:3072 sc1 lds
    s_mov_b32 m0, 14336
    s_nop 0
    buffer_load_dwordx4 v17, s[44:47], s13 offen sc1 lds
    s_add_u32 s13, s95, 230400
    s_mov_b32 m0, 15360
    s_nop 0
    buffer_load_dwordx4 v16, s[44:47], s13 offen offset:0 sc1 lds
    buffer_load_dwordx4 v16, s[44:47], s13 offen offset:1024 sc1 lds
    buffer_load_dwordx4 v16, s[44:47], s13 offen offset:2048 sc1 lds
    buffer_load_dwordx4 v16, s[44:47], s13 offen offset:3072 sc1 lds
    s_mov_b32 m0, 19456
    s_nop 0
    buffer_load_dwordx4 v17, s[44:47], s13 offen sc1 lds
    s_waitcnt vmcnt(0)
    v_mov_b32 v12, 1
    s_mov_b64 exec, 1
    ds_write_b32 v0, v12 offset:36
    s_mov_b64 exec, -1
    s_waitcnt lgkmcnt(0)
    s_cmp_lg_u32 s2, 0
    s_cbranch_scc1 L_end
    s_mov_b32 s12, 65536
    s_movk_i32 s11, 4096
L_ep:
    buffer_load_dwordx4 v[24:27], v16, s[44:47], s11 offen offset:0 sc1
    buffer_load_dwordx4 v[28:31], v16, s[44:47], s11 offen offset:1024 sc1
    buffer_load_dwordx4 v[32:35], v16, s[44:47], s11 offen offset:2048 sc1
    buffer_load_dwordx4 v[36:39], v16, s[44:47], s11 offen offset:3072 sc1
    s_waitcnt vmcnt(0)
    v_xor_b32 v24, s10, v24
    v_xor_b32 v25, s10, v25
    v_xor_b32 v26, s10, v26
    v_xor_b32 v27, s10, v27
    v_xor_b32 v28, s10, v28
    v_xor_b32 v29, s10, v29
    v_xor_b32 v30, s10, v30
    v_xor_b32 v31, s10, v31
    v_xor_b32 v32, s10, v32
    v_xor_b32 v33, s10, v33
    v_xor_b32 v34, s10, v34
    v_xor_b32 v35, s10, v35
    v_xor_b32 v36, s10, v36
    v_xor_b32 v37, s10, v37
    v_xor_b32 v38, s10, v38
    v_xor_b32 v39, s10, v39
    v_or_b32 v24, v24, v25
    v_or_b32 v24, v24, v26
    v_or_b32 v24, v24, v27
    v_or_b32 v24, v24, v28
    v_or_b32 v24, v24, v29
    v_or_b32 v24, v24, v30
    v_or_b32 v24, v24, v31
    v_or_b32 v24, v24, v32
    v_or_b32 v24, v24, v33
    v_or_b32 v24, v24, v34
    v_or_b32 v24, v24, v35
    v_or_b32 v24, v24, v36
    v_or_b32 v24, v24, v37
    v_or_b32 v24, v24, v38
    v_or_b32 v24, v24, v39
    v_cmp_ne_u32 vcc, 0, v24
    s_sub_u32 s12, s12, 1
    s_cselect_b64 vcc, 0, vcc
    s_cmp_eq_u64 vcc, 0
    s_cbranch_scc0 L_ep
    v_mov_b32 v18, s10
    v_mov_b32 v19, 0
    s_mov_b64 exec, 1
    buffer_store_dword v18, v19, s[44:47], 0 offen sc1
    s_endpgm
L_comp:
    s_waitcnt lgkmcnt(0)
    s_load_dword s10, s[42:43], 0
    s_cmp_eq_u32 s3, 3
    s_cbranch_scc1 L_nos1
    s_mov_b64 s[56:57], s[18:19]
    s_mov_b32 s58, 2621440
    s_mov_b32 s59, 0x20000
    s_mov_b64 s[60:61], s[20:21]
    s_mov_b32 s62, 2621440
    s_mov_b32 s63, 0x20000
    s_mov_b64 s[64:65], s[22:23]
    s_mov_b32 s66, 5120
    s_mov_b32 s67, 0x20000
    s_lshl_b32 s11, s3, 6
    v_add_u32 v158, s11, v1
    v_mul_u32_u24 v159, 3277, v158
    v_lshrrev_b32 v159, 16, v159
    v_mul_u32_u24 v46, 20, v159
    v_sub_u32 v46, v158, v46
    s_mul_i32 s11, s8, 81920
    s_mul_i32 s12, s9, 160
    s_add_u32 s11, s11, s12
    v_mul_u32_u24 v42, 10240, v159
    v_lshl_add_u32 v42, v46, 3, v42
    v_add_u32 v42, s11, v42
    s_lshl_b32 s12, s12, 2
    v_lshlrev_b32 v44, 5, v46
    v_add_u32 v44, s12, v44
    v_cmp_gt_u32 vcc, 160, v158
    v_mov_b32 v47, 2147483648
    v_mul_u32_u24 v45, 576, v46
    v_cndmask_b32 v42, v47, v42, vcc
    v_subrev_u32 v40, 3840, v42
    v_add_u32 v43, 5120, v42
    buffer_load_dwordx4 v[126:129], v44, s[64:67], 0 offen
    buffer_load_dwordx4 v[130:133], v44, s[64:67], 0 offen offset:16
    buffer_load_dwordx2 v[136:137], v40, s[56:59], 0 offen offset:0
    buffer_load_dwordx2 v[138:139], v40, s[56:59], 0 offen offset:1280
    buffer_load_dwordx2 v[140:141], v40, s[56:59], 0 offen offset:2560
    buffer_load_dwordx2 v[142:143], v42, s[56:59], 0 offen offset:0
    buffer_load_dwordx2 v[144:145], v42, s[56:59], 0 offen offset:1280
    buffer_load_dwordx2 v[146:147], v42, s[56:59], 0 offen offset:2560
    buffer_load_dwordx2 v[148:149], v42, s[56:59], 0 offen offset:3840
    buffer_load_dwordx2 v[150:151], v43, s[56:59], 0 offen offset:0
    buffer_load_dwordx2 v[152:153], v43, s[56:59], 0 offen offset:1280
    buffer_load_dwordx2 v[154:155], v43, s[56:59], 0 offen offset:2560
    buffer_load_dwordx2 v[156:157], v43, s[56:59], 0 offen offset:3840
    buffer_load_dwordx2 v[48:49], v42, s[60:63], 0 offen offset:0
    buffer_load_dwordx2 v[50:51], v42, s[60:63], 0 offen offset:1280
    buffer_load_dwordx2 v[52:53], v42, s[60:63], 0 offen offset:2560
    buffer_load_dwordx2 v[54:55], v42, s[60:63], 0 offen offset:3840
    buffer_load_dwordx2 v[56:57], v43, s[60:63], 0 offen offset:0
    buffer_load_dwordx2 v[58:59], v43, s[60:63], 0 offen offset:1280
    buffer_load_dwordx2 v[60:61], v43, s[60:63], 0 offen offset:2560
    buffer_load_dwordx2 v[62:63], v43, s[60:63], 0 offen offset:3840
    v_lshlrev_b32 v159, 4, v159
    v_sub_u32 v45, v45, v159
    v_add_u32 v45, 139376, v45
    v_mov_b32 v47, 158976
    v_cndmask_b32 v45, v47, v45, vcc
    v_lshrrev_b32 v158, 4, v1
    v_bfe_u32 v159, v1, 2, 2
    v_lshl_add_u32 v159, v158, 3, v159
    v_mul_u32_u24 v159, 192, v159
    v_and_b32 v46, 3, v1
    v_lshl_add_u32 v159, v46, 3, v159
    v_and_b32 v47, 1, v158
    s_and_b32 s13, s3, 1
    s_add_u32 s11, s13, 2
    v_xor_b32 v46, s11, v47
    v_lshl_add_u32 v24, v46, 5, v159
    s_lshl_b32 s11, s13, 2
    v_xor_b32 v46, s11, v47
    v_lshl_add_u32 v25, v46, 5, v159
    s_add_u32 s11, s11, 1
    v_xor_b32 v46, s11, v47
    v_lshl_add_u32 v26, v46, 5, v159
    v_and_b32 v46, 31, v1
    v_lshlrev_b32 v21, 2, v46
    v_and_b32 v46, 15, v1
    v_bfe_u32 v47, v1, 1, 3
    v_xor_b32 v47, v47, v158
    v_lshlrev_b32 v47, 4, v47
    v_lshl_add_u32 v47, v46, 7, v47
    s_lshr_b32 s11, s3, 1
    s_lshl_b32 s11, s11, 13
    s_add_u32 s11, s11, 73728
    v_add_u32 v33, s11, v47
    v_xor_b32 v34, 64, v33
    v_lshlrev_b32 v22, 2, v46
    s_lshl_b32 s11, s3, 10
    s_add_u32 s11, s11, 116736
    v_lshlrev_b32 v9, 3, v1
    v_add_u32 v9, s11, v9
    v_lshlrev_b32 v2, 4, v1
    v_add_u32 v4, 4096, v2
    s_mul_i32 s92, s3, 5120
    s_mul_i32 s95, s3, 2560
    v_add_u32 v13, s92, v2
    v_mul_u32_u24 v47, 160, v46
    v_lshrrev_b32 v134, 4, v1
    v_lshl_add_u32 v47, v134, 3, v47
    v_add_u32 v15, s92, v47
    s_add_u32 s11, s95, 106496
    v_add_u32 v14, s11, v47
    v_lshlrev_b32 v47, 3, v1
    v_add_u32 v16, s92, v47
    v_lshrrev_b32 v47, 1, v1
    v_and_b32 v134, 1, v1
    v_lshlrev_b32 v134, 4, v134
    v_lshl_add_u32 v20, v47, 12, v134
    s_lshr_b32 s11, s3, 1
    s_lshl1_add_u32 s11, s6, s11
    s_mul_i32 s12, s11, 196608
    s_mul_i32 s13, s7, 12288
    s_add_u32 s12, s12, s13
    s_and_b32 s13, s3, 1
    s_add_u32 s12, s12, 6291456
    s_lshl_b32 s14, s13, 13
    s_add_u32 s88, s12, s14
    s_lshl_b32 s14, s13, 11
    s_add_u32 s87, s12, s14
    s_add_u32 s87, s87, 4096
    s_lshl_b32 s11, s11, 7
    s_lshl3_add_u32 s11, s7, s11
    s_lshl2_add_u32 s11, s13, s11
    s_add_u32 s89, s11, 8192
    s_mov_b32 s99, 0xbfb8aa3b
    s_mul_i32 s11, s3, 12
    s_mul_i32 s12, s9, 48
    s_add_u32 s12, s12, s11
    s_mul_i32 s91, s12, 5120
    s_add_u32 s91, s91, 4194304
    s_mul_i32 s12, s8, 48
    s_add_u32 s12, s12, s11
    s_lshl_b32 s90, s12, 12
    s_add_u32 s90, s90, 6291456
    s_lshl2_add_u32 s11, s8, s3
    s_mul_i32 s93, s11, 20480
    s_mul_i32 s12, s9, 160
    s_add_u32 s93, s93, s12
    s_lshl_b32 s94, s11, 6
    s_add_u32 s94, s94, 32768
    s_lshl_b32 s98, s11, 5
    s_mul_i32 s12, s9, 327680
    s_add_u32 s98, s98, s12
    s_add_u32 s98, s98, 12582912
    s_lshl_b32 s96, s8, 7
    s_add_u32 s96, s96, 8192
    s_mul_i32 s97, s9, 320
    s_add_u32 s97, s97, 24576
    s_mov_b32 s14, 1985229328
    s_mov_b32 s15, 4275878552
    s_lshl_b32 s11, s3, 4
    s_lshr_b64 s[14:15], s[14:15], s11
    s_mul_i32 s12, s3, 49152
    s_sub_u32 s90, s90, s12
    s_mul_i32 s12, s3, 61440
    s_sub_u32 s91, s91, s12
    s_mov_b32 s86, 0
    s_bfe_u32 s11, s14, 262144
    s_mul_i32 s12, s11, 12288
    s_add_u32 s72, s90, s12
    s_mul_i32 s12, s11, 15360
    s_add_u32 s76, s91, s12
    s_lshl_b32 s11, s11, 1
    s_lshl_b32 s11, 3, s11
    s_or_b32 s86, s86, s11
    s_add_u32 s11, s3, 0
    s_and_b32 s11, s11, 3
    s_lshl_b32 s12, s11, 10
    v_add_u32 v5, s12, v2
    s_bfe_u32 s11, s14, 262148
    s_mul_i32 s12, s11, 12288
    s_add_u32 s73, s90, s12
    s_mul_i32 s12, s11, 15360
    s_add_u32 s77, s91, s12
    s_lshl_b32 s11, s11, 1
    s_lshl_b32 s11, 3, s11
    s_or_b32 s86, s86, s11
    s_add_u32 s11, s3, 1
    s_and_b32 s11, s11, 3
    s_lshl_b32 s12, s11, 10
    v_add_u32 v6, s12, v2
    s_sub_u32 s11, s3, 1
    s_and_b32 s11, s11, 3
    s_mul_i32 s11, s11, 5120
    s_add_u32 s11, s11, 45056
    v_add_u32 v17, s11, v2
    s_bfe_u32 s11, s14, 262152
    s_mul_i32 s12, s11, 12288
    s_add_u32 s74, s90, s12
    s_mul_i32 s12, s11, 15360
    s_add_u32 s78, s91, s12
    s_lshl_b32 s11, s11, 1
    s_lshl_b32 s11, 3, s11
    s_or_b32 s86, s86, s11
    s_add_u32 s11, s3, 2
    s_and_b32 s11, s11, 3
    s_lshl_b32 s12, s11, 10
    v_add_u32 v7, s12, v2
    s_sub_u32 s11, s3, 2
    s_and_b32 s11, s11, 3
    s_mul_i32 s11, s11, 5120
    s_add_u32 s11, s11, 65536
    v_add_u32 v18, s11, v2
    s_bfe_u32 s11, s14, 262156
    s_mul_i32 s12, s11, 12288
    s_add_u32 s75, s90, s12
    s_mul_i32 s12, s11, 15360
    s_add_u32 s79, s91, s12
    s_lshl_b32 s11, s11, 1
    s_lshl_b32 s11, 3, s11
    s_or_b32 s86, s86, s11
    s_add_u32 s11, s3, 3
    s_and_b32 s11, s11, 3
    s_lshl_b32 s12, s11, 10
    v_add_u32 v8, s12, v2
    s_sub_u32 s11, s3, 3
    s_and_b32 s11, s11, 3
    s_mul_i32 s11, s11, 5120
    s_add_u32 s11, s11, 86016
    v_add_u32 v19, s11, v2
    v_add_u32 v158, 0, v1
    v_mul_u32_u24 v159, 6554, v158
    v_lshrrev_b32 v159, 16, v159
    v_mul_u32_u24 v46, 10, v159
    v_sub_u32 v46, v158, v46
    v_lshlrev_b32 v46, 4, v46
    v_mul_u32_u24 v159, 1280, v159
    v_add_u32 v10, v159, v46
    v_add_u32 v158, 64, v1
    v_mul_u32_u24 v159, 6554, v158
    v_lshrrev_b32 v159, 16, v159
    v_mul_u32_u24 v46, 10, v159
    v_sub_u32 v46, v158, v46
    v_lshlrev_b32 v46, 4, v46
    v_mul_u32_u24 v159, 1280, v159
    v_add_u32 v11, v159, v46
    v_add_u32 v158, 128, v1
    v_mul_u32_u24 v159, 6554, v158
    v_lshrrev_b32 v159, 16, v159
    v_mul_u32_u24 v46, 10, v159
    v_sub_u32 v46, v158, v46
    v_lshlrev_b32 v46, 4, v46
    v_mul_u32_u24 v159, 1280, v159
    v_add_u32 v12, v159, v46
    v_cmp_gt_u32 vcc, 32, v1
    v_mov_b32 v158, 2147483648
    s_nop 0
    v_cndmask_b32 v12, v158, v12, vcc
    v_mov_b32 v160, 0
    v_mov_b32 v161, 0
    v_mov_b32 v162, 0
    v_mov_b32 v163, 0
    v_mov_b32 v164, 0
    v_mov_b32 v165, 0
    v_mov_b32 v166, 0
    v_mov_b32 v167, 0
    v_mov_b32 v168, 0
    v_mov_b32 v169, 0
    v_mov_b32 v170, 0
    v_mov_b32 v171, 0
    v_mov_b32 v172, 0
    v_mov_b32 v173, 0
    v_mov_b32 v174, 0
    v_mov_b32 v175, 0
    v_mov_b32 v176, 0
    v_mov_b32 v177, 0
    v_mov_b32 v178, 0
    v_mov_b32 v179, 0
    v_mov_b32 v180, 0
    v_mov_b32 v181, 0
    v_mov_b32 v182, 0
    v_mov_b32 v183, 0
    v_mov_b32 v184, 0
    v_mov_b32 v185, 0
    v_mov_b32 v186, 0
    v_mov_b32 v187, 0
    v_mov_b32 v188, 0
    v_mov_b32 v189, 0
    v_mov_b32 v190, 0
    v_mov_b32 v191, 0
    v_mov_b32 v192, 0
    v_mov_b32 v193, 0
    v_mov_b32 v194, 0
    v_mov_b32 v195, 0
    v_mov_b32 v196, 0
    v_mov_b32 v197, 0
    v_mov_b32 v198, 0
    v_mov_b32 v199, 0
    v_mov_b32 v200, 0
    v_mov_b32 v201, 0
    v_mov_b32 v202, 0
    v_mov_b32 v203, 0
    v_mov_b32 v204, 0
    v_mov_b32 v205, 0
    v_mov_b32 v206, 0
    v_mov_b32 v207, 0
    v_mov_b32 v208, 0
    v_mov_b32 v209, 0
    v_mov_b32 v210, 0
    v_mov_b32 v211, 0
    v_mov_b32 v212, 0
    v_mov_b32 v213, 0
    v_mov_b32 v214, 0
    v_mov_b32 v215, 0
    v_mov_b32 v216, 0
    v_mov_b32 v217, 0
    v_mov_b32 v218, 0
    v_mov_b32 v219, 0
    v_mov_b32 v220, 0
    v_mov_b32 v221, 0
    v_mov_b32 v222, 0
    v_mov_b32 v223, 0
    v_mov_b32 v224, 0
    v_mov_b32 v225, 0
    v_mov_b32 v226, 0
    v_mov_b32 v227, 0
    v_mov_b32 v228, 0
    v_mov_b32 v229, 0
    v_mov_b32 v230, 0
    v_mov_b32 v231, 0
    v_mov_b32 v232, 0
    v_mov_b32 v233, 0
    v_mov_b32 v234, 0
    v_mov_b32 v235, 0
    v_mov_b32 v236, 0
    v_mov_b32 v237, 0
    v_mov_b32 v238, 0
    v_mov_b32 v239, 0
    v_mov_b32 v240, 0
    v_mov_b32 v241, 0
    v_mov_b32 v242, 0
    v_mov_b32 v243, 0
    v_mov_b32 v244, 0
    v_mov_b32 v245, 0
    v_mov_b32 v246, 0
    v_mov_b32 v247, 0
    v_mov_b32 v248, 0
    v_mov_b32 v249, 0
    v_mov_b32 v250, 0
    v_mov_b32 v251, 0
    v_mov_b32 v252, 0
    v_mov_b32 v253, 0
    v_mov_b32 v254, 0
    v_mov_b32 v255, 0
    s_waitcnt vmcnt(19)
    v_lshlrev_b32 v64, 16, v126
    v_and_b32 v66, s101, v126
    v_lshlrev_b32 v68, 16, v127
    v_and_b32 v70, s101, v127
    v_lshlrev_b32 v65, 16, v128
    v_and_b32 v67, s101, v128
    v_lshlrev_b32 v69, 16, v129
    v_and_b32 v71, s101, v129
    v_lshlrev_b32 v72, 16, v130
    v_and_b32 v74, s101, v130
    v_lshlrev_b32 v76, 16, v131
    v_and_b32 v78, s101, v131
    v_lshlrev_b32 v73, 16, v132
    v_and_b32 v75, s101, v132
    v_lshlrev_b32 v77, 16, v133
    v_and_b32 v79, s101, v133
    s_waitcnt vmcnt(18)
    v_lshlrev_b32 v80, 16, v136
    v_and_b32 v81, s101, v136
    v_lshlrev_b32 v102, 16, v137
    v_and_b32 v103, s101, v137
    s_waitcnt vmcnt(17)
    v_lshlrev_b32 v82, 16, v138
    v_and_b32 v83, s101, v138
    v_lshlrev_b32 v104, 16, v139
    v_and_b32 v105, s101, v139
    s_waitcnt vmcnt(16)
    v_lshlrev_b32 v84, 16, v140
    v_and_b32 v85, s101, v140
    v_lshlrev_b32 v106, 16, v141
    v_and_b32 v107, s101, v141
    s_waitcnt vmcnt(15)
    v_lshlrev_b32 v86, 16, v142
    v_and_b32 v87, s101, v142
    v_lshlrev_b32 v108, 16, v143
    v_and_b32 v109, s101, v143
    v_pk_mul_f32 v[80:81], v[80:81], v[70:71]
    v_pk_fma_f32 v[80:81], v[82:83], v[68:69], v[80:81]
    v_pk_fma_f32 v[80:81], v[84:85], v[66:67], v[80:81]
    v_pk_fma_f32 v[80:81], v[86:87], v[64:65], v[80:81]
    v_pk_mul_f32 v[102:103], v[102:103], v[78:79]
    v_pk_fma_f32 v[102:103], v[104:105], v[76:77], v[102:103]
    v_pk_fma_f32 v[102:103], v[106:107], v[74:75], v[102:103]
    v_pk_fma_f32 v[102:103], v[108:109], v[72:73], v[102:103]
    s_waitcnt vmcnt(14)
    v_lshlrev_b32 v88, 16, v144
    v_and_b32 v89, s101, v144
    v_lshlrev_b32 v110, 16, v145
    v_and_b32 v111, s101, v145
    v_pk_mul_f32 v[82:83], v[82:83], v[70:71]
    v_pk_fma_f32 v[82:83], v[84:85], v[68:69], v[82:83]
    v_pk_fma_f32 v[82:83], v[86:87], v[66:67], v[82:83]
    v_pk_fma_f32 v[82:83], v[88:89], v[64:65], v[82:83]
    v_pk_mul_f32 v[104:105], v[104:105], v[78:79]
    v_pk_fma_f32 v[104:105], v[106:107], v[76:77], v[104:105]
    v_pk_fma_f32 v[104:105], v[108:109], v[74:75], v[104:105]
    v_pk_fma_f32 v[104:105], v[110:111], v[72:73], v[104:105]
    s_waitcnt vmcnt(13)
    v_lshlrev_b32 v90, 16, v146
    v_and_b32 v91, s101, v146
    v_lshlrev_b32 v112, 16, v147
    v_and_b32 v113, s101, v147
    v_pk_mul_f32 v[84:85], v[84:85], v[70:71]
    v_pk_fma_f32 v[84:85], v[86:87], v[68:69], v[84:85]
    v_pk_fma_f32 v[84:85], v[88:89], v[66:67], v[84:85]
    v_pk_fma_f32 v[84:85], v[90:91], v[64:65], v[84:85]
    v_pk_mul_f32 v[106:107], v[106:107], v[78:79]
    v_pk_fma_f32 v[106:107], v[108:109], v[76:77], v[106:107]
    v_pk_fma_f32 v[106:107], v[110:111], v[74:75], v[106:107]
    v_pk_fma_f32 v[106:107], v[112:113], v[72:73], v[106:107]
    s_waitcnt vmcnt(12)
    v_lshlrev_b32 v92, 16, v148
    v_and_b32 v93, s101, v148
    v_lshlrev_b32 v114, 16, v149
    v_and_b32 v115, s101, v149
    v_pk_mul_f32 v[86:87], v[86:87], v[70:71]
    v_pk_fma_f32 v[86:87], v[88:89], v[68:69], v[86:87]
    v_pk_fma_f32 v[86:87], v[90:91], v[66:67], v[86:87]
    v_pk_fma_f32 v[86:87], v[92:93], v[64:65], v[86:87]
    v_pk_mul_f32 v[108:109], v[108:109], v[78:79]
    v_pk_fma_f32 v[108:109], v[110:111], v[76:77], v[108:109]
    v_pk_fma_f32 v[108:109], v[112:113], v[74:75], v[108:109]
    v_pk_fma_f32 v[108:109], v[114:115], v[72:73], v[108:109]
    s_waitcnt vmcnt(11)
    v_lshlrev_b32 v94, 16, v150
    v_and_b32 v95, s101, v150
    v_lshlrev_b32 v116, 16, v151
    v_and_b32 v117, s101, v151
    v_pk_mul_f32 v[88:89], v[88:89], v[70:71]
    v_pk_fma_f32 v[88:89], v[90:91], v[68:69], v[88:89]
    v_pk_fma_f32 v[88:89], v[92:93], v[66:67], v[88:89]
    v_pk_fma_f32 v[88:89], v[94:95], v[64:65], v[88:89]
    v_pk_mul_f32 v[110:111], v[110:111], v[78:79]
    v_pk_fma_f32 v[110:111], v[112:113], v[76:77], v[110:111]
    v_pk_fma_f32 v[110:111], v[114:115], v[74:75], v[110:111]
    v_pk_fma_f32 v[110:111], v[116:117], v[72:73], v[110:111]
    s_waitcnt vmcnt(10)
    v_lshlrev_b32 v96, 16, v152
    v_and_b32 v97, s101, v152
    v_lshlrev_b32 v118, 16, v153
    v_and_b32 v119, s101, v153
    v_pk_mul_f32 v[90:91], v[90:91], v[70:71]
    v_pk_fma_f32 v[90:91], v[92:93], v[68:69], v[90:91]
    v_pk_fma_f32 v[90:91], v[94:95], v[66:67], v[90:91]
    v_pk_fma_f32 v[90:91], v[96:97], v[64:65], v[90:91]
    v_pk_mul_f32 v[112:113], v[112:113], v[78:79]
    v_pk_fma_f32 v[112:113], v[114:115], v[76:77], v[112:113]
    v_pk_fma_f32 v[112:113], v[116:117], v[74:75], v[112:113]
    v_pk_fma_f32 v[112:113], v[118:119], v[72:73], v[112:113]
    s_waitcnt vmcnt(9)
    v_lshlrev_b32 v98, 16, v154
    v_and_b32 v99, s101, v154
    v_lshlrev_b32 v120, 16, v155
    v_and_b32 v121, s101, v155
    v_pk_mul_f32 v[92:93], v[92:93], v[70:71]
    v_pk_fma_f32 v[92:93], v[94:95], v[68:69], v[92:93]
    v_pk_fma_f32 v[92:93], v[96:97], v[66:67], v[92:93]
    v_pk_fma_f32 v[92:93], v[98:99], v[64:65], v[92:93]
    v_pk_mul_f32 v[114:115], v[114:115], v[78:79]
    v_pk_fma_f32 v[114:115], v[116:117], v[76:77], v[114:115]
    v_pk_fma_f32 v[114:115], v[118:119], v[74:75], v[114:115]
    v_pk_fma_f32 v[114:115], v[120:121], v[72:73], v[114:115]
    s_waitcnt vmcnt(8)
    v_lshlrev_b32 v100, 16, v156
    v_and_b32 v101, s101, v156
    v_lshlrev_b32 v122, 16, v157
    v_and_b32 v123, s101, v157
    v_pk_mul_f32 v[94:95], v[94:95], v[70:71]
    v_pk_fma_f32 v[94:95], v[96:97], v[68:69], v[94:95]
    v_pk_fma_f32 v[94:95], v[98:99], v[66:67], v[94:95]
    v_pk_fma_f32 v[94:95], v[100:101], v[64:65], v[94:95]
    v_pk_mul_f32 v[116:117], v[116:117], v[78:79]
    v_pk_fma_f32 v[116:117], v[118:119], v[76:77], v[116:117]
    v_pk_fma_f32 v[116:117], v[120:121], v[74:75], v[116:117]
    v_pk_fma_f32 v[116:117], v[122:123], v[72:73], v[116:117]
    s_waitcnt vmcnt(7)
    v_lshlrev_b32 v124, 16, v48
    v_and_b32 v125, s101, v48
    v_pk_mul_f32 v[80:81], v[80:81], v[124:125]
    v_lshlrev_b32 v124, 16, v49
    v_and_b32 v125, s101, v49
    v_pk_mul_f32 v[102:103], v[102:103], v[124:125]
    s_waitcnt vmcnt(6)
    v_lshlrev_b32 v124, 16, v50
    v_and_b32 v125, s101, v50
    v_pk_mul_f32 v[82:83], v[82:83], v[124:125]
    v_lshlrev_b32 v124, 16, v51
    v_and_b32 v125, s101, v51
    v_pk_mul_f32 v[104:105], v[104:105], v[124:125]
    s_waitcnt vmcnt(5)
    v_lshlrev_b32 v124, 16, v52
    v_and_b32 v125, s101, v52
    v_pk_mul_f32 v[84:85], v[84:85], v[124:125]
    v_lshlrev_b32 v124, 16, v53
    v_and_b32 v125, s101, v53
    v_pk_mul_f32 v[106:107], v[106:107], v[124:125]
    s_waitcnt vmcnt(4)
    v_lshlrev_b32 v124, 16, v54
    v_and_b32 v125, s101, v54
    v_pk_mul_f32 v[86:87], v[86:87], v[124:125]
    v_lshlrev_b32 v124, 16, v55
    v_and_b32 v125, s101, v55
    v_pk_mul_f32 v[108:109], v[108:109], v[124:125]
    s_waitcnt vmcnt(3)
    v_lshlrev_b32 v124, 16, v56
    v_and_b32 v125, s101, v56
    v_pk_mul_f32 v[88:89], v[88:89], v[124:125]
    v_lshlrev_b32 v124, 16, v57
    v_and_b32 v125, s101, v57
    v_pk_mul_f32 v[110:111], v[110:111], v[124:125]
    s_waitcnt vmcnt(2)
    v_lshlrev_b32 v124, 16, v58
    v_and_b32 v125, s101, v58
    v_pk_mul_f32 v[90:91], v[90:91], v[124:125]
    v_lshlrev_b32 v124, 16, v59
    v_and_b32 v125, s101, v59
    v_pk_mul_f32 v[112:113], v[112:113], v[124:125]
    s_waitcnt vmcnt(1)
    v_lshlrev_b32 v124, 16, v60
    v_and_b32 v125, s101, v60
    v_pk_mul_f32 v[92:93], v[92:93], v[124:125]
    v_lshlrev_b32 v124, 16, v61
    v_and_b32 v125, s101, v61
    v_pk_mul_f32 v[114:115], v[114:115], v[124:125]
    s_waitcnt vmcnt(0)
    v_lshlrev_b32 v124, 16, v62
    v_and_b32 v125, s101, v62
    v_pk_mul_f32 v[94:95], v[94:95], v[124:125]
    v_lshlrev_b32 v124, 16, v63
    v_and_b32 v125, s101, v63
    v_pk_mul_f32 v[116:117], v[116:117], v[124:125]
    v_cvt_pk_bf16_f32 v136, v94, v92
    v_cvt_pk_bf16_f32 v137, v90, v88
    v_cvt_pk_bf16_f32 v138, v86, v84
    v_cvt_pk_bf16_f32 v139, v82, v80
    ds_write_b128 v45, v[136:139] offset:0
    v_cvt_pk_bf16_f32 v140, v95, v93
    v_cvt_pk_bf16_f32 v141, v91, v89
    v_cvt_pk_bf16_f32 v142, v87, v85
    v_cvt_pk_bf16_f32 v143, v83, v81
    ds_write_b128 v45, v[140:143] offset:144
    v_cvt_pk_bf16_f32 v144, v116, v114
    v_cvt_pk_bf16_f32 v145, v112, v110
    v_cvt_pk_bf16_f32 v146, v108, v106
    v_cvt_pk_bf16_f32 v147, v104, v102
    ds_write_b128 v45, v[144:147] offset:288
    v_cvt_pk_bf16_f32 v148, v117, v115
    v_cvt_pk_bf16_f32 v149, v113, v111
    v_cvt_pk_bf16_f32 v150, v109, v107
    v_cvt_pk_bf16_f32 v151, v105, v103
    ds_write_b128 v45, v[148:151] offset:432
    s_waitcnt lgkmcnt(0)
    s_branch L_s1done
L_nos1:
    s_mov_b64 s[56:57], s[38:39]
    s_mov_b32 s58, 2621440
    s_mov_b32 s59, 0x20000
    s_mov_b64 s[60:61], s[24:25]
    s_mov_b32 s62, 2621440
    s_mov_b32 s63, 0x20000
    s_mov_b64 s[64:65], s[34:35]
    s_mov_b32 s66, 1966080
    s_mov_b32 s67, 0x20000
    s_mov_b64 s[44:45], s[42:43]
    s_mov_b32 s46, 16777216
    s_mov_b32 s47, 0x20000
    v_lshlrev_b32 v126, 21, v1
    s_mov_b64 exec, 0xff
    buffer_load_dword v127, v126, s[44:47], 0 offen
    buffer_load_dword v128, v126, s[56:59], 0 offen
    buffer_load_dword v129, v126, s[60:63], 0 offen
    buffer_load_dword v130, v126, s[64:67], 0 offen
    s_mov_b64 exec, -1
L_nos1b:
    v_lshrrev_b32 v158, 4, v1
    v_bfe_u32 v159, v1, 2, 2
    v_lshl_add_u32 v159, v158, 3, v159
    v_mul_u32_u24 v159, 192, v159
    v_and_b32 v46, 3, v1
    v_lshl_add_u32 v159, v46, 3, v159
    v_and_b32 v47, 1, v158
    s_and_b32 s13, s3, 1
    s_add_u32 s11, s13, 2
    v_xor_b32 v46, s11, v47
    v_lshl_add_u32 v24, v46, 5, v159
    s_lshl_b32 s11, s13, 2
    v_xor_b32 v46, s11, v47
    v_lshl_add_u32 v25, v46, 5, v159
    s_add_u32 s11, s11, 1
    v_xor_b32 v46, s11, v47
    v_lshl_add_u32 v26, v46, 5, v159
    v_and_b32 v46, 31, v1
    v_lshlrev_b32 v21, 2, v46
    v_and_b32 v46, 15, v1
    v_bfe_u32 v47, v1, 1, 3
    v_xor_b32 v47, v47, v158
    v_lshlrev_b32 v47, 4, v47
    v_lshl_add_u32 v47, v46, 7, v47
    s_lshr_b32 s11, s3, 1
    s_lshl_b32 s11, s11, 13
    s_add_u32 s11, s11, 73728
    v_add_u32 v33, s11, v47
    v_xor_b32 v34, 64, v33
    v_lshlrev_b32 v22, 2, v46
    s_lshl_b32 s11, s3, 10
    s_add_u32 s11, s11, 116736
    v_lshlrev_b32 v9, 3, v1
    v_add_u32 v9, s11, v9
    v_lshlrev_b32 v2, 4, v1
    v_add_u32 v4, 4096, v2
    s_mul_i32 s92, s3, 5120
    s_mul_i32 s95, s3, 2560
    v_add_u32 v13, s92, v2
    v_mul_u32_u24 v47, 160, v46
    v_lshrrev_b32 v134, 4, v1
    v_lshl_add_u32 v47, v134, 3, v47
    v_add_u32 v15, s92, v47
    s_add_u32 s11, s95, 106496
    v_add_u32 v14, s11, v47
    v_lshlrev_b32 v47, 3, v1
    v_add_u32 v16, s92, v47
    v_lshrrev_b32 v47, 1, v1
    v_and_b32 v134, 1, v1
    v_lshlrev_b32 v134, 4, v134
    v_lshl_add_u32 v20, v47, 12, v134
    s_lshr_b32 s11, s3, 1
    s_lshl1_add_u32 s11, s6, s11
    s_mul_i32 s12, s11, 196608
    s_mul_i32 s13, s7, 12288
    s_add_u32 s12, s12, s13
    s_and_b32 s13, s3, 1
    s_add_u32 s12, s12, 6291456
    s_lshl_b32 s14, s13, 13
    s_add_u32 s88, s12, s14
    s_lshl_b32 s14, s13, 11
    s_add_u32 s87, s12, s14
    s_add_u32 s87, s87, 4096
    s_lshl_b32 s11, s11, 7
    s_lshl3_add_u32 s11, s7, s11
    s_lshl2_add_u32 s11, s13, s11
    s_add_u32 s89, s11, 8192
    s_mov_b32 s99, 0xbfb8aa3b
    s_mul_i32 s11, s3, 12
    s_mul_i32 s12, s9, 48
    s_add_u32 s12, s12, s11
    s_mul_i32 s91, s12, 5120
    s_add_u32 s91, s91, 4194304
    s_mul_i32 s12, s8, 48
    s_add_u32 s12, s12, s11
    s_lshl_b32 s90, s12, 12
    s_add_u32 s90, s90, 6291456
    s_lshl2_add_u32 s11, s8, s3
    s_mul_i32 s93, s11, 20480
    s_mul_i32 s12, s9, 160
    s_add_u32 s93, s93, s12
    s_lshl_b32 s94, s11, 6
    s_add_u32 s94, s94, 32768
    s_lshl_b32 s98, s11, 5
    s_mul_i32 s12, s9, 327680
    s_add_u32 s98, s98, s12
    s_add_u32 s98, s98, 12582912
    s_lshl_b32 s96, s8, 7
    s_add_u32 s96, s96, 8192
    s_mul_i32 s97, s9, 320
    s_add_u32 s97, s97, 24576
    s_mov_b32 s14, 1985229328
    s_mov_b32 s15, 4275878552
    s_lshl_b32 s11, s3, 4
    s_lshr_b64 s[14:15], s[14:15], s11
    s_mul_i32 s12, s3, 49152
    s_sub_u32 s90, s90, s12
    s_mul_i32 s12, s3, 61440
    s_sub_u32 s91, s91, s12
    s_mov_b32 s86, 0
    s_bfe_u32 s11, s14, 262144
    s_mul_i32 s12, s11, 12288
    s_add_u32 s72, s90, s12
    s_mul_i32 s12, s11, 15360
    s_add_u32 s76, s91, s12
    s_lshl_b32 s11, s11, 1
    s_lshl_b32 s11, 3, s11
    s_or_b32 s86, s86, s11
    s_add_u32 s11, s3, 0
    s_and_b32 s11, s11, 3
    s_lshl_b32 s12, s11, 10
    v_add_u32 v5, s12, v2
    s_bfe_u32 s11, s14, 262148
    s_mul_i32 s12, s11, 12288
    s_add_u32 s73, s90, s12
    s_mul_i32 s12, s11, 15360
    s_add_u32 s77, s91, s12
    s_lshl_b32 s11, s11, 1
    s_lshl_b32 s11, 3, s11
    s_or_b32 s86, s86, s11
    s_add_u32 s11, s3, 1
    s_and_b32 s11, s11, 3
    s_lshl_b32 s12, s11, 10
    v_add_u32 v6, s12, v2
    s_sub_u32 s11, s3, 1
    s_and_b32 s11, s11, 3
    s_mul_i32 s11, s11, 5120
    s_add_u32 s11, s11, 45056
    v_add_u32 v17, s11, v2
    s_bfe_u32 s11, s14, 262152
    s_mul_i32 s12, s11, 12288
    s_add_u32 s74, s90, s12
    s_mul_i32 s12, s11, 15360
    s_add_u32 s78, s91, s12
    s_lshl_b32 s11, s11, 1
    s_lshl_b32 s11, 3, s11
    s_or_b32 s86, s86, s11
    s_add_u32 s11, s3, 2
    s_and_b32 s11, s11, 3
    s_lshl_b32 s12, s11, 10
    v_add_u32 v7, s12, v2
    s_sub_u32 s11, s3, 2
    s_and_b32 s11, s11, 3
    s_mul_i32 s11, s11, 5120
    s_add_u32 s11, s11, 65536
    v_add_u32 v18, s11, v2
    s_bfe_u32 s11, s14, 262156
    s_mul_i32 s12, s11, 12288
    s_add_u32 s75, s90, s12
    s_mul_i32 s12, s11, 15360
    s_add_u32 s79, s91, s12
    s_lshl_b32 s11, s11, 1
    s_lshl_b32 s11, 3, s11
    s_or_b32 s86, s86, s11
    s_add_u32 s11, s3, 3
    s_and_b32 s11, s11, 3
    s_lshl_b32 s12, s11, 10
    v_add_u32 v8, s12, v2
    s_sub_u32 s11, s3, 3
    s_and_b32 s11, s11, 3
    s_mul_i32 s11, s11, 5120
    s_add_u32 s11, s11, 86016
    v_add_u32 v19, s11, v2
    v_add_u32 v158, 0, v1
    v_mul_u32_u24 v159, 6554, v158
    v_lshrrev_b32 v159, 16, v159
    v_mul_u32_u24 v46, 10, v159
    v_sub_u32 v46, v158, v46
    v_lshlrev_b32 v46, 4, v46
    v_mul_u32_u24 v159, 1280, v159
    v_add_u32 v10, v159, v46
    v_add_u32 v158, 64, v1
    v_mul_u32_u24 v159, 6554, v158
    v_lshrrev_b32 v159, 16, v159
    v_mul_u32_u24 v46, 10, v159
    v_sub_u32 v46, v158, v46
    v_lshlrev_b32 v46, 4, v46
    v_mul_u32_u24 v159, 1280, v159
    v_add_u32 v11, v159, v46
    v_add_u32 v158, 128, v1
    v_mul_u32_u24 v159, 6554, v158
    v_lshrrev_b32 v159, 16, v159
    v_mul_u32_u24 v46, 10, v159
    v_sub_u32 v46, v158, v46
    v_lshlrev_b32 v46, 4, v46
    v_mul_u32_u24 v159, 1280, v159
    v_add_u32 v12, v159, v46
    v_cmp_gt_u32 vcc, 32, v1
    v_mov_b32 v158, 2147483648
    s_nop 0
    v_cndmask_b32 v12, v158, v12, vcc
    v_mov_b32 v160, 0
    v_mov_b32 v161, 0
    v_mov_b32 v162, 0
    v_mov_b32 v163, 0
    v_mov_b32 v164, 0
    v_mov_b32 v165, 0
    v_mov_b32 v166, 0
    v_mov_b32 v167, 0
    v_mov_b32 v168, 0
    v_mov_b32 v169, 0
    v_mov_b32 v170, 0
    v_mov_b32 v171, 0
    v_mov_b32 v172, 0
    v_mov_b32 v173, 0
    v_mov_b32 v174, 0
    v_mov_b32 v175, 0
    v_mov_b32 v176, 0
    v_mov_b32 v177, 0
    v_mov_b32 v178, 0
    v_mov_b32 v179, 0
    v_mov_b32 v180, 0
    v_mov_b32 v181, 0
    v_mov_b32 v182, 0
    v_mov_b32 v183, 0
    v_mov_b32 v184, 0
    v_mov_b32 v185, 0
    v_mov_b32 v186, 0
    v_mov_b32 v187, 0
    v_mov_b32 v188, 0
    v_mov_b32 v189, 0
    v_mov_b32 v190, 0
    v_mov_b32 v191, 0
    v_mov_b32 v192, 0
    v_mov_b32 v193, 0
    v_mov_b32 v194, 0
    v_mov_b32 v195, 0
    v_mov_b32 v196, 0
    v_mov_b32 v197, 0
    v_mov_b32 v198, 0
    v_mov_b32 v199, 0
    v_mov_b32 v200, 0
    v_mov_b32 v201, 0
    v_mov_b32 v202, 0
    v_mov_b32 v203, 0
    v_mov_b32 v204, 0
    v_mov_b32 v205, 0
    v_mov_b32 v206, 0
    v_mov_b32 v207, 0
    v_mov_b32 v208, 0
    v_mov_b32 v209, 0
    v_mov_b32 v210, 0
    v_mov_b32 v211, 0
    v_mov_b32 v212, 0
    v_mov_b32 v213, 0
    v_mov_b32 v214, 0
    v_mov_b32 v215, 0
    v_mov_b32 v216, 0
    v_mov_b32 v217, 0
    v_mov_b32 v218, 0
    v_mov_b32 v219, 0
    v_mov_b32 v220, 0
    v_mov_b32 v221, 0
    v_mov_b32 v222, 0
    v_mov_b32 v223, 0
    v_mov_b32 v224, 0
    v_mov_b32 v225, 0
    v_mov_b32 v226, 0
    v_mov_b32 v227, 0
    v_mov_b32 v228, 0
    v_mov_b32 v229, 0
    v_mov_b32 v230, 0
    v_mov_b32 v231, 0
    v_mov_b32 v232, 0
    v_mov_b32 v233, 0
    v_mov_b32 v234, 0
    v_mov_b32 v235, 0
    v_mov_b32 v236, 0
    v_mov_b32 v237, 0
    v_mov_b32 v238, 0
    v_mov_b32 v239, 0
    v_mov_b32 v240, 0
    v_mov_b32 v241, 0
    v_mov_b32 v242, 0
    v_mov_b32 v243, 0
    v_mov_b32 v244, 0
    v_mov_b32 v245, 0
    v_mov_b32 v246, 0
    v_mov_b32 v247, 0
    v_mov_b32 v248, 0
    v_mov_b32 v249, 0
    v_mov_b32 v250, 0
    v_mov_b32 v251, 0
    v_mov_b32 v252, 0
    v_mov_b32 v253, 0
    v_mov_b32 v254, 0
    v_mov_b32 v255, 0
L_s1done:
    s_mov_b64 s[44:45], s[42:43]
    s_mov_b32 s46, 16777216
    s_mov_b32 s47, 0x20000
    s_mov_b64 s[48:49], s[16:17]
    s_mov_b32 s50, 2621440
    s_mov_b32 s51, 0x20000
    s_waitcnt vmcnt(0)
    s_waitcnt lgkmcnt(0)
    s_mul_i32 s10, s10, 0x9E3779B1
    s_add_u32 s10, s10, 0x7F4A7C15
    s_setprio 1
    s_barrier
    ds_read_b128 v[72:75], v33
    ds_read_b64_tr_b16 v[48:49], v24 offset:0
    ds_read_b64_tr_b16 v[50:51], v24 offset:768
    ds_read_b64_tr_b16 v[52:53], v24 offset:6144
    ds_read_b64_tr_b16 v[54:55], v24 offset:6912
    ds_read_b64_tr_b16 v[56:57], v25 offset:0
    ds_read_b64_tr_b16 v[58:59], v25 offset:768
    ds_read_b64_tr_b16 v[60:61], v25 offset:6144
    ds_read_b64_tr_b16 v[62:63], v25 offset:6912
    ds_read_b64_tr_b16 v[64:65], v26 offset:0
    ds_read_b64_tr_b16 v[66:67], v26 offset:768
    ds_read_b64_tr_b16 v[68:69], v26 offset:6144
    ds_read_b64_tr_b16 v[70:71], v26 offset:6912
    ds_read_b128 v[76:79], v33 offset:2048
    ds_read_b128 v[80:83], v33 offset:4096
    ds_read_b128 v[84:87], v33 offset:6144
    s_mov_b32 s68, 12288
    s_mov_b32 s70, 0
    s_mov_b32 s69, 10
    s_mov_b32 m0, 16
    v_add_u32 v27, s68, v24
    v_add_u32 v28, s68, v25
    v_add_u32 v29, s68, v26
    v_mov_b32 v35, v34
    s_waitcnt lgkmcnt(0)
L_g1:
    s_waitcnt lgkmcnt(0)
    v_mfma_f32_16x16x32_bf16 v[160:163], v[48:51], v[72:75], v[160:163]
    s_barrier
    v_mfma_f32_16x16x32_bf16 v[176:179], v[52:55], v[72:75], v[176:179]
    ds_read_b128 v[112:115], v35
    ds_read_b64_tr_b16 v[88:89], v27 offset:0
    v_mfma_f32_16x16x32_bf16 v[192:195], v[56:59], v[72:75], v[192:195]
    ds_read_b64_tr_b16 v[90:91], v27 offset:768
    ds_read_b64_tr_b16 v[92:93], v27 offset:6144
    v_mfma_f32_16x16x32_bf16 v[208:211], v[60:63], v[72:75], v[208:211]
    ds_read_b64_tr_b16 v[94:95], v27 offset:6912
    ds_read_b64_tr_b16 v[96:97], v28 offset:0
    v_mfma_f32_16x16x32_bf16 v[224:227], v[64:67], v[72:75], v[224:227]
    ds_read_b64_tr_b16 v[98:99], v28 offset:768
    ds_read_b64_tr_b16 v[100:101], v28 offset:6144
    v_mfma_f32_16x16x32_bf16 v[240:243], v[68:71], v[72:75], v[240:243]
    ds_read_b64_tr_b16 v[102:103], v28 offset:6912
    ds_read_b64_tr_b16 v[104:105], v29 offset:0
    v_mfma_f32_16x16x32_bf16 v[164:167], v[48:51], v[76:79], v[164:167]
    ds_read_b64_tr_b16 v[106:107], v29 offset:768
    ds_read_b64_tr_b16 v[108:109], v29 offset:6144
    v_mfma_f32_16x16x32_bf16 v[180:183], v[52:55], v[76:79], v[180:183]
    ds_read_b64_tr_b16 v[110:111], v29 offset:6912
    ds_read_b128 v[116:119], v35 offset:2048
    v_mfma_f32_16x16x32_bf16 v[196:199], v[56:59], v[76:79], v[196:199]
    ds_read_b128 v[120:123], v35 offset:4096
    ds_read_b128 v[124:127], v35 offset:6144
    v_mfma_f32_16x16x32_bf16 v[212:215], v[60:63], v[76:79], v[212:215]
    v_mfma_f32_16x16x32_bf16 v[228:231], v[64:67], v[76:79], v[228:231]
    v_mfma_f32_16x16x32_bf16 v[244:247], v[68:71], v[76:79], v[244:247]
    v_mfma_f32_16x16x32_bf16 v[168:171], v[48:51], v[80:83], v[168:171]
    v_mfma_f32_16x16x32_bf16 v[184:187], v[52:55], v[80:83], v[184:187]
    v_mfma_f32_16x16x32_bf16 v[200:203], v[56:59], v[80:83], v[200:203]
    v_mfma_f32_16x16x32_bf16 v[216:219], v[60:63], v[80:83], v[216:219]
    v_mfma_f32_16x16x32_bf16 v[232:235], v[64:67], v[80:83], v[232:235]
    v_mfma_f32_16x16x32_bf16 v[248:251], v[68:71], v[80:83], v[248:251]
    s_add_u32 s68, s68, 12288
    s_cmp_eq_u32 s68, 73728
    v_mfma_f32_16x16x32_bf16 v[172:175], v[48:51], v[84:87], v[172:175]
    s_cselect_b32 s68, 0, s68
    v_add_u32 v30, s68, v24
    v_mfma_f32_16x16x32_bf16 v[188:191], v[52:55], v[84:87], v[188:191]
    v_add_u32 v31, s68, v25
    v_add_u32 v32, s68, v26
    v_mfma_f32_16x16x32_bf16 v[204:207], v[56:59], v[84:87], v[204:207]
    s_add_u32 s70, s70, 16384
    v_mfma_f32_16x16x32_bf16 v[220:223], v[60:63], v[84:87], v[220:223]
    s_and_b32 s70, s70, 65535
    v_mfma_f32_16x16x32_bf16 v[236:239], v[64:67], v[84:87], v[236:239]
    v_add_u32 v36, s70, v33
    v_mfma_f32_16x16x32_bf16 v[252:255], v[68:71], v[84:87], v[252:255]
    s_waitcnt lgkmcnt(0)
    v_mfma_f32_16x16x32_bf16 v[160:163], v[88:91], v[112:115], v[160:163]
    s_barrier
    v_mfma_f32_16x16x32_bf16 v[176:179], v[92:95], v[112:115], v[176:179]
    ds_read_b128 v[72:75], v36
    ds_read_b64_tr_b16 v[48:49], v30 offset:0
    v_mfma_f32_16x16x32_bf16 v[192:195], v[96:99], v[112:115], v[192:195]
    ds_read_b64_tr_b16 v[50:51], v30 offset:768
    ds_read_b64_tr_b16 v[52:53], v30 offset:6144
    v_mfma_f32_16x16x32_bf16 v[208:211], v[100:103], v[112:115], v[208:211]
    ds_read_b64_tr_b16 v[54:55], v30 offset:6912
    ds_read_b64_tr_b16 v[56:57], v31 offset:0
    v_mfma_f32_16x16x32_bf16 v[224:227], v[104:107], v[112:115], v[224:227]
    ds_read_b64_tr_b16 v[58:59], v31 offset:768
    ds_read_b64_tr_b16 v[60:61], v31 offset:6144
    v_mfma_f32_16x16x32_bf16 v[240:243], v[108:111], v[112:115], v[240:243]
    ds_read_b64_tr_b16 v[62:63], v31 offset:6912
    ds_read_b64_tr_b16 v[64:65], v32 offset:0
    v_mfma_f32_16x16x32_bf16 v[164:167], v[88:91], v[116:119], v[164:167]
    ds_read_b64_tr_b16 v[66:67], v32 offset:768
    ds_read_b64_tr_b16 v[68:69], v32 offset:6144
    v_mfma_f32_16x16x32_bf16 v[180:183], v[92:95], v[116:119], v[180:183]
    ds_read_b64_tr_b16 v[70:71], v32 offset:6912
    ds_read_b128 v[76:79], v36 offset:2048
    v_mfma_f32_16x16x32_bf16 v[196:199], v[96:99], v[116:119], v[196:199]
    ds_read_b128 v[80:83], v36 offset:4096
    ds_read_b128 v[84:87], v36 offset:6144
    v_mfma_f32_16x16x32_bf16 v[212:215], v[100:103], v[116:119], v[212:215]
    v_mfma_f32_16x16x32_bf16 v[228:231], v[104:107], v[116:119], v[228:231]
    v_mfma_f32_16x16x32_bf16 v[244:247], v[108:111], v[116:119], v[244:247]
    v_mfma_f32_16x16x32_bf16 v[168:171], v[88:91], v[120:123], v[168:171]
    v_mfma_f32_16x16x32_bf16 v[184:187], v[92:95], v[120:123], v[184:187]
    v_mfma_f32_16x16x32_bf16 v[200:203], v[96:99], v[120:123], v[200:203]
    v_mfma_f32_16x16x32_bf16 v[216:219], v[100:103], v[120:123], v[216:219]
    v_mfma_f32_16x16x32_bf16 v[232:235], v[104:107], v[120:123], v[232:235]
    v_mfma_f32_16x16x32_bf16 v[248:251], v[108:111], v[120:123], v[248:251]
    s_add_u32 s68, s68, 12288
    s_cmp_eq_u32 s68, 73728
    v_mfma_f32_16x16x32_bf16 v[172:175], v[88:91], v[124:127], v[172:175]
    s_cselect_b32 s68, 0, s68
    v_add_u32 v27, s68, v24
    v_mfma_f32_16x16x32_bf16 v[188:191], v[92:95], v[124:127], v[188:191]
    v_add_u32 v28, s68, v25
    v_add_u32 v29, s68, v26
    v_mfma_f32_16x16x32_bf16 v[204:207], v[96:99], v[124:127], v[204:207]
    v_add_u32 v35, s70, v34
    v_mfma_f32_16x16x32_bf16 v[220:223], v[100:103], v[124:127], v[220:223]
    v_mfma_f32_16x16x32_bf16 v[236:239], v[104:107], v[124:127], v[236:239]
    v_mfma_f32_16x16x32_bf16 v[252:255], v[108:111], v[124:127], v[252:255]
    s_sub_u32 s69, s69, 1
    s_cmp_lg_u32 s69, 0
    s_cbranch_scc1 L_g1
    s_setprio 3
    s_waitcnt lgkmcnt(0)
    s_barrier
    v_mul_f32 v160, s99, v160
    v_mul_f32 v161, s99, v161
    v_exp_f32 v160, v160
    v_mul_f32 v162, s99, v162
    v_exp_f32 v161, v161
    v_mul_f32 v163, s99, v163
    v_exp_f32 v162, v162
    v_mul_f32 v164, s99, v164
    v_add_f32 v160, 1.0, v160
    v_exp_f32 v163, v163
    v_mul_f32 v165, s99, v165
    v_add_f32 v161, 1.0, v161
    v_rcp_f32 v160, v160
    v_exp_f32 v164, v164
    v_mul_f32 v166, s99, v166
    v_add_f32 v162, 1.0, v162
    v_rcp_f32 v161, v161
    v_exp_f32 v165, v165
    v_mul_f32 v167, s99, v167
    v_add_f32 v163, 1.0, v163
    v_rcp_f32 v162, v162
    v_mul_f32 v160, v160, v176
    v_exp_f32 v166, v166
    v_mul_f32 v168, s99, v168
    v_add_f32 v164, 1.0, v164
    v_rcp_f32 v163, v163
    v_mul_f32 v161, v161, v177
    v_exp_f32 v167, v167
    v_mul_f32 v169, s99, v169
    v_add_f32 v165, 1.0, v165
    v_rcp_f32 v164, v164
    v_mul_f32 v162, v162, v178
    v_exp_f32 v168, v168
    v_mul_f32 v170, s99, v170
    v_add_f32 v166, 1.0, v166
    v_rcp_f32 v165, v165
    v_mul_f32 v163, v163, v179
    v_exp_f32 v169, v169
    v_mul_f32 v171, s99, v171
    v_add_f32 v167, 1.0, v167
    v_rcp_f32 v166, v166
    v_mul_f32 v164, v164, v180
    v_exp_f32 v170, v170
    v_mul_f32 v172, s99, v172
    v_add_f32 v168, 1.0, v168
    v_rcp_f32 v167, v167
    v_mul_f32 v165, v165, v181
    v_exp_f32 v171, v171
    v_mul_f32 v173, s99, v173
    v_add_f32 v169, 1.0, v169
    v_rcp_f32 v168, v168
    v_mul_f32 v166, v166, v182
    v_exp_f32 v172, v172
    v_mul_f32 v174, s99, v174
    v_add_f32 v170, 1.0, v170
    v_rcp_f32 v169, v169
    v_mul_f32 v167, v167, v183
    v_exp_f32 v173, v173
    v_mul_f32 v175, s99, v175
    v_add_f32 v171, 1.0, v171
    v_rcp_f32 v170, v170
    v_mul_f32 v168, v168, v184
    v_exp_f32 v174, v174
    v_mul_f32 v192, s99, v192
    v_add_f32 v172, 1.0, v172
    v_rcp_f32 v171, v171
    v_mul_f32 v169, v169, v185
    v_exp_f32 v175, v175
    v_mul_f32 v193, s99, v193
    v_add_f32 v173, 1.0, v173
    v_rcp_f32 v172, v172
    v_mul_f32 v170, v170, v186
    v_exp_f32 v192, v192
    v_mul_f32 v194, s99, v194
    v_add_f32 v174, 1.0, v174
    v_rcp_f32 v173, v173
    v_mul_f32 v171, v171, v187
    v_exp_f32 v193, v193
    v_mul_f32 v195, s99, v195
    v_add_f32 v175, 1.0, v175
    v_rcp_f32 v174, v174
    v_mul_f32 v172, v172, v188
    v_exp_f32 v194, v194
    v_mul_f32 v224, s99, v224
    v_add_f32 v192, 1.0, v192
    v_rcp_f32 v175, v175
    v_mul_f32 v173, v173, v189
    v_exp_f32 v195, v195
    v_mul_f32 v225, s99, v225
    v_add_f32 v193, 1.0, v193
    v_rcp_f32 v192, v192
    v_mul_f32 v174, v174, v190
    v_exp_f32 v224, v224
    v_mul_f32 v226, s99, v226
    v_add_f32 v194, 1.0, v194
    v_rcp_f32 v193, v193
    v_mul_f32 v175, v175, v191
    s_bitcmp1_b32 s3, 0
    s_cbranch_scc1 L_xa1
    v_cvt_pk_bf16_f32 v40, v160, v161
    v_cvt_pk_bf16_f32 v41, v162, v163
    v_cvt_pk_bf16_f32 v44, v164, v165
    v_cvt_pk_bf16_f32 v45, v166, v167
    v_cvt_pk_bf16_f32 v148, v168, v169
    v_cvt_pk_bf16_f32 v149, v170, v171
    v_cvt_pk_bf16_f32 v150, v172, v173
    v_cvt_pk_bf16_f32 v151, v174, v175
    s_branch L_xa2
L_xa1:
    v_cvt_pk_bf16_f32 v42, v168, v169
    v_cvt_pk_bf16_f32 v43, v170, v171
    v_cvt_pk_bf16_f32 v46, v172, v173
    v_cvt_pk_bf16_f32 v47, v174, v175
    v_cvt_pk_bf16_f32 v148, v160, v161
    v_cvt_pk_bf16_f32 v149, v162, v163
    v_cvt_pk_bf16_f32 v150, v164, v165
    v_cvt_pk_bf16_f32 v151, v166, v167
L_xa2:
    ds_write_b64 v9, v[148:149]
    ds_write_b64 v9, v[150:151] offset:512
    s_lshr_b32 s11, s3, 1
    s_lshl_b32 s11, s11, 2
    v_add_u32 v152, s11, v0
    v_mov_b32 v153, 1
    v_xor_b32 v9, 0x400, v9
    s_mov_b64 exec, 1
    ds_add_u32 v152, v153 offset:16
    s_mov_b64 exec, -1
    v_exp_f32 v225, v225
    v_mul_f32 v227, s99, v227
    v_add_f32 v195, 1.0, v195
    v_rcp_f32 v194, v194
    v_mul_f32 v192, v192, v208
    v_exp_f32 v226, v226
    v_mul_f32 v196, s99, v196
    v_add_f32 v224, 1.0, v224
    v_rcp_f32 v195, v195
    v_mul_f32 v193, v193, v209
    v_exp_f32 v227, v227
    v_mul_f32 v197, s99, v197
    v_add_f32 v225, 1.0, v225
    v_rcp_f32 v224, v224
    v_mul_f32 v194, v194, v210
    v_exp_f32 v196, v196
    v_mul_f32 v198, s99, v198
    v_add_f32 v226, 1.0, v226
    v_rcp_f32 v225, v225
    v_mul_f32 v195, v195, v211
    v_exp_f32 v197, v197
    v_mul_f32 v199, s99, v199
    v_add_f32 v227, 1.0, v227
    v_rcp_f32 v226, v226
    v_mul_f32 v224, v224, v240
    v_exp_f32 v198, v198
    v_mul_f32 v228, s99, v228
    v_add_f32 v196, 1.0, v196
    v_rcp_f32 v227, v227
    v_mul_f32 v225, v225, v241
    v_exp_f32 v199, v199
    v_mul_f32 v229, s99, v229
    v_add_f32 v197, 1.0, v197
    v_rcp_f32 v196, v196
    v_mul_f32 v226, v226, v242
    v_exp_f32 v228, v228
    v_mul_f32 v230, s99, v230
    v_add_f32 v198, 1.0, v198
    v_rcp_f32 v197, v197
    v_mul_f32 v227, v227, v243
    v_cvt_pk_bf16_f32 v24, v192, v193
    v_cvt_pk_bf16_f32 v25, v194, v195
    v_cvt_pk_bf16_f32 v26, v224, v225
    v_cvt_pk_bf16_f32 v27, v226, v227
    buffer_store_dwordx4 v[24:27], v2, s[44:47], s88 offen offset:0 sc1
    ds_read_b32 v153, v152 offset:16
    s_bitcmp1_b32 s3, 0
    s_cbranch_scc1 L_xb1
    ds_read_b64 v[42:43], v9
    ds_read_b64 v[46:47], v9 offset:512
    s_branch L_xb2
L_xb1:
    ds_read_b64 v[40:41], v9
    ds_read_b64 v[44:45], v9 offset:512
L_xb2:
    v_exp_f32 v229, v229
    v_mul_f32 v231, s99, v231
    v_add_f32 v199, 1.0, v199
    v_rcp_f32 v198, v198
    v_mul_f32 v196, v196, v212
    v_exp_f32 v230, v230
    v_mul_f32 v200, s99, v200
    v_add_f32 v228, 1.0, v228
    v_rcp_f32 v199, v199
    v_mul_f32 v197, v197, v213
    v_exp_f32 v231, v231
    v_mul_f32 v201, s99, v201
    v_add_f32 v229, 1.0, v229
    v_rcp_f32 v228, v228
    v_mul_f32 v198, v198, v214
    v_exp_f32 v200, v200
    v_mul_f32 v202, s99, v202
    v_add_f32 v230, 1.0, v230
    v_rcp_f32 v229, v229
    v_mul_f32 v199, v199, v215
    v_exp_f32 v201, v201
    v_mul_f32 v203, s99, v203
    v_add_f32 v231, 1.0, v231
    v_rcp_f32 v230, v230
    v_mul_f32 v228, v228, v244
    v_exp_f32 v202, v202
    v_mul_f32 v232, s99, v232
    v_add_f32 v200, 1.0, v200
    v_rcp_f32 v231, v231
    v_mul_f32 v229, v229, v245
    v_exp_f32 v203, v203
    v_mul_f32 v233, s99, v233
    v_add_f32 v201, 1.0, v201
    v_rcp_f32 v200, v200
    v_mul_f32 v230, v230, v246
    v_exp_f32 v232, v232
    v_mul_f32 v234, s99, v234
    v_add_f32 v202, 1.0, v202
    v_rcp_f32 v201, v201
    v_mul_f32 v231, v231, v247
    v_cvt_pk_bf16_f32 v28, v196, v197
    v_cvt_pk_bf16_f32 v29, v198, v199
    v_cvt_pk_bf16_f32 v30, v228, v229
    v_cvt_pk_bf16_f32 v31, v230, v231
    buffer_store_dwordx4 v[28:31], v2, s[44:47], s88 offen offset:1024 sc1
    s_mov_b32 s12, 1048576
    s_branch L_xchk
L_xs:
    ds_read_b32 v153, v152 offset:16
    s_bitcmp1_b32 s3, 0
    s_cbranch_scc1 L_xb1r
    ds_read_b64 v[42:43], v9
    ds_read_b64 v[46:47], v9 offset:512
    s_branch L_xb2r
L_xb1r:
    ds_read_b64 v[40:41], v9
    ds_read_b64 v[44:45], v9 offset:512
L_xb2r:
L_xchk:
    s_waitcnt lgkmcnt(0)
    v_readfirstlane_b32 s11, v153
    s_sub_u32 s12, s12, 1
    s_cselect_b32 s11, 2, s11
    s_cmp_lt_u32 s11, 2
    s_cbranch_scc1 L_xs
    buffer_store_dwordx4 v[40:43], v2, s[44:47], s87 offen offset:0 sc1
    buffer_store_dwordx4 v[44:47], v2, s[44:47], s87 offen offset:1024 sc1
    v_exp_f32 v233, v233
    v_mul_f32 v235, s99, v235
    v_add_f32 v203, 1.0, v203
    v_rcp_f32 v202, v202
    v_mul_f32 v200, v200, v216
    v_exp_f32 v234, v234
    v_mul_f32 v204, s99, v204
    v_add_f32 v232, 1.0, v232
    v_rcp_f32 v203, v203
    v_mul_f32 v201, v201, v217
    v_exp_f32 v235, v235
    v_mul_f32 v205, s99, v205
    v_add_f32 v233, 1.0, v233
    v_rcp_f32 v232, v232
    v_mul_f32 v202, v202, v218
    v_exp_f32 v204, v204
    v_mul_f32 v206, s99, v206
    v_add_f32 v234, 1.0, v234
    v_rcp_f32 v233, v233
    v_mul_f32 v203, v203, v219
    v_exp_f32 v205, v205
    v_mul_f32 v207, s99, v207
    v_add_f32 v235, 1.0, v235
    v_rcp_f32 v234, v234
    v_mul_f32 v232, v232, v248
    v_exp_f32 v206, v206
    v_mul_f32 v236, s99, v236
    v_add_f32 v204, 1.0, v204
    v_rcp_f32 v235, v235
    v_mul_f32 v233, v233, v249
    v_exp_f32 v207, v207
    v_mul_f32 v237, s99, v237
    v_add_f32 v205, 1.0, v205
    v_rcp_f32 v204, v204
    v_mul_f32 v234, v234, v250
    v_exp_f32 v236, v236
    v_mul_f32 v238, s99, v238
    v_add_f32 v206, 1.0, v206
    v_rcp_f32 v205, v205
    v_mul_f32 v235, v235, v251
    v_cvt_pk_bf16_f32 v32, v200, v201
    v_cvt_pk_bf16_f32 v33, v202, v203
    v_cvt_pk_bf16_f32 v34, v232, v233
    v_cvt_pk_bf16_f32 v35, v234, v235
    buffer_store_dwordx4 v[32:35], v2, s[44:47], s88 offen offset:2048 sc1
    v_exp_f32 v237, v237
    v_mul_f32 v239, s99, v239
    v_add_f32 v207, 1.0, v207
    v_rcp_f32 v206, v206
    v_mul_f32 v204, v204, v220
    v_exp_f32 v238, v238
    v_add_f32 v236, 1.0, v236
    v_rcp_f32 v207, v207
    v_mul_f32 v205, v205, v221
    v_exp_f32 v239, v239
    v_add_f32 v237, 1.0, v237
    v_rcp_f32 v236, v236
    v_mul_f32 v206, v206, v222
    v_add_f32 v238, 1.0, v238
    v_rcp_f32 v237, v237
    v_mul_f32 v207, v207, v223
    v_add_f32 v239, 1.0, v239
    v_rcp_f32 v238, v238
    v_mul_f32 v236, v236, v252
    v_rcp_f32 v239, v239
    v_mul_f32 v237, v237, v253
    v_mul_f32 v238, v238, v254
    v_mul_f32 v239, v239, v255
    v_cvt_pk_bf16_f32 v36, v204, v205
    v_cvt_pk_bf16_f32 v37, v206, v207
    v_cvt_pk_bf16_f32 v38, v236, v237
    v_cvt_pk_bf16_f32 v39, v238, v239
    buffer_store_dwordx4 v[36:39], v2, s[44:47], s88 offen offset:3072 sc1
    v_mov_b32 v176, 0
    v_mov_b32 v177, 0
    v_mov_b32 v178, 0
    v_mov_b32 v179, 0
    v_mov_b32 v180, 0
    v_mov_b32 v181, 0
    v_mov_b32 v182, 0
    v_mov_b32 v183, 0
    v_mov_b32 v184, 0
    v_mov_b32 v185, 0
    v_mov_b32 v186, 0
    v_mov_b32 v187, 0
    v_mov_b32 v188, 0
    v_mov_b32 v189, 0
    v_mov_b32 v190, 0
    v_mov_b32 v191, 0
    v_mov_b32 v192, 0
    v_mov_b32 v193, 0
    v_mov_b32 v194, 0
    v_mov_b32 v195, 0
    v_mov_b32 v196, 0
    v_mov_b32 v197, 0
    v_mov_b32 v198, 0
    v_mov_b32 v199, 0
    v_mov_b32 v200, 0
    v_mov_b32 v201, 0
    v_mov_b32 v202, 0
    v_mov_b32 v203, 0
    v_mov_b32 v204, 0
    v_mov_b32 v205, 0
    v_mov_b32 v206, 0
    v_mov_b32 v207, 0
    v_mov_b32 v208, 0
    v_mov_b32 v209, 0
    v_mov_b32 v210, 0
    v_mov_b32 v211, 0
    v_mov_b32 v212, 0
    v_mov_b32 v213, 0
    v_mov_b32 v214, 0
    v_mov_b32 v215, 0
    v_mov_b32 v216, 0
    v_mov_b32 v217, 0
    v_mov_b32 v218, 0
    v_mov_b32 v219, 0
    v_mov_b32 v220, 0
    v_mov_b32 v221, 0
    v_mov_b32 v222, 0
    v_mov_b32 v223, 0
    v_mov_b32 v224, 0
    v_mov_b32 v225, 0
    v_mov_b32 v226, 0
    v_mov_b32 v227, 0
    v_mov_b32 v228, 0
    v_mov_b32 v229, 0
    v_mov_b32 v230, 0
    v_mov_b32 v231, 0
    v_mov_b32 v232, 0
    v_mov_b32 v233, 0
    v_mov_b32 v234, 0
    v_mov_b32 v235, 0
    v_mov_b32 v236, 0
    v_mov_b32 v237, 0
    v_mov_b32 v238, 0
    v_mov_b32 v239, 0
    v_mov_b32 v240, 0
    v_mov_b32 v241, 0
    v_mov_b32 v242, 0
    v_mov_b32 v243, 0
    v_mov_b32 v244, 0
    v_mov_b32 v245, 0
    v_mov_b32 v246, 0
    v_mov_b32 v247, 0
    v_mov_b32 v248, 0
    v_mov_b32 v249, 0
    v_mov_b32 v250, 0
    v_mov_b32 v251, 0
    v_mov_b32 v252, 0
    v_mov_b32 v253, 0
    v_mov_b32 v254, 0
    v_mov_b32 v255, 0
    s_mov_b32 s12, 1048576
    s_branch L_ls4_rd
L_ls4:
    s_sleep 1
L_ls4_rd:
    ds_read_b32 v148, v0 offset:44
    s_waitcnt lgkmcnt(0)
    v_readfirstlane_b32 s11, v148
    s_sub_u32 s12, s12, 1
    s_cselect_b32 s11, -1, s11
    s_cmp_lt_u32 s11, 1
    s_cbranch_scc1 L_ls4
    s_waitcnt vmcnt(0)
    v_mov_b32 v148, s10
    v_mov_b32 v149, 0
    s_mov_b64 exec, 1
    buffer_store_dword v148, v149, s[44:47], s89 offen sc1
    s_mov_b64 exec, -1
    s_add_u32 s89, s89, 0x1000
    v_mov_b32 v150, 1
    s_mov_b64 exec, 1
    ds_add_u32 v0, v150 offset:40
    s_mov_b64 exec, -1
    s_mov_b32 s12, 1048576
    s_branch L_ls5_rd
L_ls5:
    s_sleep 1
L_ls5_rd:
    ds_read_b32 v150, v0 offset:40
    s_waitcnt lgkmcnt(0)
    v_readfirstlane_b32 s11, v150
    s_sub_u32 s12, s12, 1
    s_cselect_b32 s11, -1, s11
    s_cmp_lt_u32 s11, 20
    s_cbranch_scc1 L_ls5
    s_add_u32 s13, s76, 0
    buffer_load_dwordx4 v[48:51], v2, s[44:47], s13 offen offset:0 sc1
    buffer_load_dwordx4 v[52:55], v2, s[44:47], s13 offen offset:1024 sc1
    buffer_load_dwordx4 v[56:59], v2, s[44:47], s13 offen offset:2048 sc1
    buffer_load_dwordx4 v[60:63], v2, s[44:47], s13 offen offset:3072 sc1
    buffer_load_dwordx4 v[64:67], v4, s[44:47], s13 offen offset:0 sc1
    s_add_u32 s13, s76, 5120
    buffer_load_dwordx4 v[68:71], v2, s[44:47], s13 offen offset:0 sc1
    buffer_load_dwordx4 v[72:75], v2, s[44:47], s13 offen offset:1024 sc1
    buffer_load_dwordx4 v[76:79], v2, s[44:47], s13 offen offset:2048 sc1
    buffer_load_dwordx4 v[80:83], v2, s[44:47], s13 offen offset:3072 sc1
    buffer_load_dwordx4 v[84:87], v4, s[44:47], s13 offen offset:0 sc1
    s_add_u32 s13, s76, 10240
    buffer_load_dwordx4 v[88:91], v2, s[44:47], s13 offen offset:0 sc1
    buffer_load_dwordx4 v[92:95], v2, s[44:47], s13 offen offset:1024 sc1
    buffer_load_dwordx4 v[96:99], v2, s[44:47], s13 offen offset:2048 sc1
    buffer_load_dwordx4 v[100:103], v2, s[44:47], s13 offen offset:3072 sc1
    buffer_load_dwordx4 v[104:107], v4, s[44:47], s13 offen offset:0 sc1
    s_add_u32 s13, s77, 0
    buffer_load_dwordx4 v[108:111], v2, s[44:47], s13 offen offset:0 sc1
    buffer_load_dwordx4 v[112:115], v2, s[44:47], s13 offen offset:1024 sc1
    buffer_load_dwordx4 v[116:119], v2, s[44:47], s13 offen offset:2048 sc1
    buffer_load_dwordx4 v[120:123], v2, s[44:47], s13 offen offset:3072 sc1
    buffer_load_dwordx4 v[124:127], v4, s[44:47], s13 offen offset:0 sc1
    s_add_u32 s13, s77, 5120
    buffer_load_dwordx4 v[128:131], v2, s[44:47], s13 offen offset:0 sc1
    buffer_load_dwordx4 v[132:135], v2, s[44:47], s13 offen offset:1024 sc1
    buffer_load_dwordx4 v[136:139], v2, s[44:47], s13 offen offset:2048 sc1
    buffer_load_dwordx4 v[140:143], v2, s[44:47], s13 offen offset:3072 sc1
    buffer_load_dwordx4 v[144:147], v4, s[44:47], s13 offen offset:0 sc1
    buffer_load_dword v172, v21, s[44:47], s96 offen sc1
    s_add_u32 m0, s95, 106496
    s_nop 0
    buffer_load_dwordx4 v10, s[48:51], s93 offen lds
    s_add_u32 m0, s95, 107520
    s_nop 0
    buffer_load_dwordx4 v11, s[48:51], s93 offen lds
    s_add_u32 m0, s95, 108544
    s_mov_b32 exec_hi, 0
    buffer_load_dwordx4 v12, s[48:51], s93 offen lds
    s_mov_b32 exec_hi, -1
    s_mov_b32 s12, 65536
    s_waitcnt vmcnt(3)
    s_branch L_spin6_chk
L_spin6:
    s_sleep 14
L_spin6_ld:
    buffer_load_dword v172, v21, s[44:47], s96 offen sc1
    s_waitcnt vmcnt(0)
L_spin6_chk:
    v_cmp_ne_u32 vcc, s10, v172
    s_sub_u32 s12, s12, 1
    s_cselect_b64 vcc, 0, vcc
    s_cmp_eq_u64 vcc, 0
    s_cbranch_scc0 L_spin6
    s_add_u32 s13, s72, 0
    buffer_load_dwordx4 v[24:27], v5, s[44:47], s13 offen sc1
    buffer_load_dwordx4 v[28:31], v6, s[44:47], s13 offen sc1
    buffer_load_dwordx4 v[32:35], v7, s[44:47], s13 offen sc1
    buffer_load_dwordx4 v[36:39], v8, s[44:47], s13 offen sc1
    s_add_u32 s13, s72, 4096
    buffer_load_dwordx4 v[148:151], v5, s[44:47], s13 offen sc1
    buffer_load_dwordx4 v[152:155], v6, s[44:47], s13 offen sc1
    buffer_load_dwordx4 v[156:159], v7, s[44:47], s13 offen sc1
    buffer_load_dwordx4 v[160:163], v8, s[44:47], s13 offen sc1
    s_add_u32 s13, s72, 8192
    buffer_load_dwordx4 v[40:43], v5, s[44:47], s13 offen sc1
    buffer_load_dwordx4 v[44:47], v6, s[44:47], s13 offen sc1
    buffer_load_dwordx4 v[164:167], v7, s[44:47], s13 offen sc1
    buffer_load_dwordx4 v[168:171], v8, s[44:47], s13 offen sc1
    buffer_load_dword v23, v22, s[44:47], s94 offen sc1
    v_min_u32 v21, 39, v1
    v_lshlrev_b32 v21, 3, v21
    s_waitcnt vmcnt(9)
    s_add_u32 s14, s73, 0
    v_mfma_f32_16x16x32_bf16 v[176:179], v[48:51], v[24:27], v[176:179]
    v_mfma_f32_16x16x32_bf16 v[180:183], v[52:55], v[24:27], v[180:183]
    v_mfma_f32_16x16x32_bf16 v[184:187], v[56:59], v[24:27], v[184:187]
    v_mfma_f32_16x16x32_bf16 v[188:191], v[60:63], v[24:27], v[188:191]
    v_mfma_f32_16x16x32_bf16 v[192:195], v[64:67], v[24:27], v[192:195]
    v_mfma_f32_16x16x32_bf16 v[196:199], v[48:51], v[28:31], v[196:199]
    v_mfma_f32_16x16x32_bf16 v[200:203], v[52:55], v[28:31], v[200:203]
    buffer_load_dwordx4 v[24:27], v5, s[44:47], s14 offen sc1
    v_mfma_f32_16x16x32_bf16 v[204:207], v[56:59], v[28:31], v[204:207]
    v_mfma_f32_16x16x32_bf16 v[208:211], v[60:63], v[28:31], v[208:211]
    v_mfma_f32_16x16x32_bf16 v[212:215], v[64:67], v[28:31], v[212:215]
    v_mfma_f32_16x16x32_bf16 v[216:219], v[48:51], v[32:35], v[216:219]
    v_mfma_f32_16x16x32_bf16 v[220:223], v[52:55], v[32:35], v[220:223]
    buffer_load_dwordx4 v[28:31], v6, s[44:47], s14 offen sc1
    v_mfma_f32_16x16x32_bf16 v[224:227], v[56:59], v[32:35], v[224:227]
    v_mfma_f32_16x16x32_bf16 v[228:231], v[60:63], v[32:35], v[228:231]
    v_mfma_f32_16x16x32_bf16 v[232:235], v[64:67], v[32:35], v[232:235]
    v_mfma_f32_16x16x32_bf16 v[236:239], v[48:51], v[36:39], v[236:239]
    v_mfma_f32_16x16x32_bf16 v[240:243], v[52:55], v[36:39], v[240:243]
    buffer_load_dwordx4 v[32:35], v7, s[44:47], s14 offen sc1
    v_mfma_f32_16x16x32_bf16 v[244:247], v[56:59], v[36:39], v[244:247]
    v_mfma_f32_16x16x32_bf16 v[248:251], v[60:63], v[36:39], v[248:251]
    v_mfma_f32_16x16x32_bf16 v[252:255], v[64:67], v[36:39], v[252:255]
    buffer_load_dwordx4 v[36:39], v8, s[44:47], s14 offen sc1
    s_waitcnt vmcnt(9)
    s_add_u32 s14, s73, 4096
    v_mfma_f32_16x16x32_bf16 v[176:179], v[68:71], v[148:151], v[176:179]
    v_mfma_f32_16x16x32_bf16 v[180:183], v[72:75], v[148:151], v[180:183]
    v_mfma_f32_16x16x32_bf16 v[184:187], v[76:79], v[148:151], v[184:187]
    v_mfma_f32_16x16x32_bf16 v[188:191], v[80:83], v[148:151], v[188:191]
    v_mfma_f32_16x16x32_bf16 v[192:195], v[84:87], v[148:151], v[192:195]
    v_mfma_f32_16x16x32_bf16 v[196:199], v[68:71], v[152:155], v[196:199]
    v_mfma_f32_16x16x32_bf16 v[200:203], v[72:75], v[152:155], v[200:203]
    buffer_load_dwordx4 v[148:151], v5, s[44:47], s14 offen sc1
    v_mfma_f32_16x16x32_bf16 v[204:207], v[76:79], v[152:155], v[204:207]
    v_mfma_f32_16x16x32_bf16 v[208:211], v[80:83], v[152:155], v[208:211]
    v_mfma_f32_16x16x32_bf16 v[212:215], v[84:87], v[152:155], v[212:215]
    v_mfma_f32_16x16x32_bf16 v[216:219], v[68:71], v[156:159], v[216:219]
    v_mfma_f32_16x16x32_bf16 v[220:223], v[72:75], v[156:159], v[220:223]
    buffer_load_dwordx4 v[152:155], v6, s[44:47], s14 offen sc1
    v_mfma_f32_16x16x32_bf16 v[224:227], v[76:79], v[156:159], v[224:227]
    v_mfma_f32_16x16x32_bf16 v[228:231], v[80:83], v[156:159], v[228:231]
    v_mfma_f32_16x16x32_bf16 v[232:235], v[84:87], v[156:159], v[232:235]
    v_mfma_f32_16x16x32_bf16 v[236:239], v[68:71], v[160:163], v[236:239]
    v_mfma_f32_16x16x32_bf16 v[240:243], v[72:75], v[160:163], v[240:243]
    buffer_load_dwordx4 v[156:159], v7, s[44:47], s14 offen sc1
    v_mfma_f32_16x16x32_bf16 v[244:247], v[76:79], v[160:163], v[244:247]
    v_mfma_f32_16x16x32_bf16 v[248:251], v[80:83], v[160:163], v[248:251]
    v_mfma_f32_16x16x32_bf16 v[252:255], v[84:87], v[160:163], v[252:255]
    buffer_load_dwordx4 v[160:163], v8, s[44:47], s14 offen sc1
    s_waitcnt vmcnt(9)
    s_add_u32 s14, s73, 8192
    v_mfma_f32_16x16x32_bf16 v[176:179], v[88:91], v[40:43], v[176:179]
    v_mfma_f32_16x16x32_bf16 v[180:183], v[92:95], v[40:43], v[180:183]
    v_mfma_f32_16x16x32_bf16 v[184:187], v[96:99], v[40:43], v[184:187]
    v_mfma_f32_16x16x32_bf16 v[188:191], v[100:103], v[40:43], v[188:191]
    v_mfma_f32_16x16x32_bf16 v[192:195], v[104:107], v[40:43], v[192:195]
    v_mfma_f32_16x16x32_bf16 v[196:199], v[88:91], v[44:47], v[196:199]
    v_mfma_f32_16x16x32_bf16 v[200:203], v[92:95], v[44:47], v[200:203]
    buffer_load_dwordx4 v[40:43], v5, s[44:47], s14 offen sc1
    v_mfma_f32_16x16x32_bf16 v[204:207], v[96:99], v[44:47], v[204:207]
    v_mfma_f32_16x16x32_bf16 v[208:211], v[100:103], v[44:47], v[208:211]
    v_mfma_f32_16x16x32_bf16 v[212:215], v[104:107], v[44:47], v[212:215]
    v_mfma_f32_16x16x32_bf16 v[216:219], v[88:91], v[164:167], v[216:219]
    v_mfma_f32_16x16x32_bf16 v[220:223], v[92:95], v[164:167], v[220:223]
    buffer_load_dwordx4 v[44:47], v6, s[44:47], s14 offen sc1
    v_mfma_f32_16x16x32_bf16 v[224:227], v[96:99], v[164:167], v[224:227]
    v_mfma_f32_16x16x32_bf16 v[228:231], v[100:103], v[164:167], v[228:231]
    v_mfma_f32_16x16x32_bf16 v[232:235], v[104:107], v[164:167], v[232:235]
    v_mfma_f32_16x16x32_bf16 v[236:239], v[88:91], v[168:171], v[236:239]
    v_mfma_f32_16x16x32_bf16 v[240:243], v[92:95], v[168:171], v[240:243]
    buffer_load_dwordx4 v[164:167], v7, s[44:47], s14 offen sc1
    v_mfma_f32_16x16x32_bf16 v[244:247], v[96:99], v[168:171], v[244:247]
    v_mfma_f32_16x16x32_bf16 v[248:251], v[100:103], v[168:171], v[248:251]
    v_mfma_f32_16x16x32_bf16 v[252:255], v[104:107], v[168:171], v[252:255]
    buffer_load_dwordx4 v[168:171], v8, s[44:47], s14 offen sc1
    s_waitcnt vmcnt(8)
    s_add_u32 s14, s74, 0
    s_add_u32 s13, s79, 5120
    v_mfma_f32_16x16x32_bf16 v[176:179], v[108:111], v[24:27], v[176:179]
    v_mfma_f32_16x16x32_bf16 v[180:183], v[112:115], v[24:27], v[180:183]
    v_mfma_f32_16x16x32_bf16 v[184:187], v[116:119], v[24:27], v[184:187]
    v_mfma_f32_16x16x32_bf16 v[188:191], v[120:123], v[24:27], v[188:191]
    buffer_load_dwordx4 v[88:91], v2, s[44:47], s13 offen offset:0 sc1
    v_mfma_f32_16x16x32_bf16 v[192:195], v[124:127], v[24:27], v[192:195]
    v_mfma_f32_16x16x32_bf16 v[196:199], v[108:111], v[28:31], v[196:199]
    buffer_load_dwordx4 v[104:107], v4, s[44:47], s13 offen offset:0 sc1
    v_mfma_f32_16x16x32_bf16 v[200:203], v[112:115], v[28:31], v[200:203]
    buffer_load_dwordx4 v[24:27], v5, s[44:47], s14 offen sc1
    v_mfma_f32_16x16x32_bf16 v[204:207], v[116:119], v[28:31], v[204:207]
    v_mfma_f32_16x16x32_bf16 v[208:211], v[120:123], v[28:31], v[208:211]
    buffer_load_dwordx4 v[92:95], v2, s[44:47], s13 offen offset:1024 sc1
    v_mfma_f32_16x16x32_bf16 v[212:215], v[124:127], v[28:31], v[212:215]
    v_mfma_f32_16x16x32_bf16 v[216:219], v[108:111], v[32:35], v[216:219]
    v_mfma_f32_16x16x32_bf16 v[220:223], v[112:115], v[32:35], v[220:223]
    buffer_load_dwordx4 v[28:31], v6, s[44:47], s14 offen sc1
    v_mfma_f32_16x16x32_bf16 v[224:227], v[116:119], v[32:35], v[224:227]
    v_mfma_f32_16x16x32_bf16 v[228:231], v[120:123], v[32:35], v[228:231]
    buffer_load_dwordx4 v[96:99], v2, s[44:47], s13 offen offset:2048 sc1
    v_mfma_f32_16x16x32_bf16 v[232:235], v[124:127], v[32:35], v[232:235]
    v_mfma_f32_16x16x32_bf16 v[236:239], v[108:111], v[36:39], v[236:239]
    v_mfma_f32_16x16x32_bf16 v[240:243], v[112:115], v[36:39], v[240:243]
    buffer_load_dwordx4 v[32:35], v7, s[44:47], s14 offen sc1
    v_mfma_f32_16x16x32_bf16 v[244:247], v[116:119], v[36:39], v[244:247]
    v_mfma_f32_16x16x32_bf16 v[248:251], v[120:123], v[36:39], v[248:251]
    buffer_load_dwordx4 v[100:103], v2, s[44:47], s13 offen offset:3072 sc1
    v_mfma_f32_16x16x32_bf16 v[252:255], v[124:127], v[36:39], v[252:255]
    buffer_load_dwordx4 v[36:39], v8, s[44:47], s14 offen sc1
    s_waitcnt vmcnt(13)
    s_mov_b32 s12, 1048576
    s_branch L_ls7_rd
L_ls7:
    s_sleep 1
L_ls7_rd:
    ds_read_b32 v175, v0 offset:36
    s_waitcnt lgkmcnt(0)
    v_readfirstlane_b32 s11, v175
    s_sub_u32 s12, s12, 1
    s_cselect_b32 s11, -1, s11
    s_cmp_lt_u32 s11, 1
    s_cbranch_scc1 L_ls7
    v_add_u32 v175, 0x10000, v13
    s_add_u32 s14, s74, 4096
    s_add_u32 s13, s79, 10240
    v_mfma_f32_16x16x32_bf16 v[176:179], v[128:131], v[148:151], v[176:179]
    ds_read_b128 v[48:51], v13 offset:24576
    v_mfma_f32_16x16x32_bf16 v[180:183], v[132:135], v[148:151], v[180:183]
    ds_read_b128 v[52:55], v13 offset:25600
    v_mfma_f32_16x16x32_bf16 v[184:187], v[136:139], v[148:151], v[184:187]
    ds_read_b128 v[56:59], v13 offset:26624
    v_mfma_f32_16x16x32_bf16 v[188:191], v[140:143], v[148:151], v[188:191]
    ds_read_b128 v[60:63], v13 offset:27648
    buffer_load_dwordx4 v[108:111], v2, s[44:47], s13 offen offset:0 sc1
    v_mfma_f32_16x16x32_bf16 v[192:195], v[144:147], v[148:151], v[192:195]
    ds_read_b128 v[64:67], v13 offset:28672
    v_mfma_f32_16x16x32_bf16 v[196:199], v[128:131], v[152:155], v[196:199]
    buffer_load_dwordx4 v[124:127], v4, s[44:47], s13 offen offset:0 sc1
    v_mfma_f32_16x16x32_bf16 v[200:203], v[132:135], v[152:155], v[200:203]
    buffer_load_dwordx4 v[148:151], v5, s[44:47], s14 offen sc1
    v_mfma_f32_16x16x32_bf16 v[204:207], v[136:139], v[152:155], v[204:207]
    v_mfma_f32_16x16x32_bf16 v[208:211], v[140:143], v[152:155], v[208:211]
    buffer_load_dwordx4 v[112:115], v2, s[44:47], s13 offen offset:1024 sc1
    v_mfma_f32_16x16x32_bf16 v[212:215], v[144:147], v[152:155], v[212:215]
    v_mfma_f32_16x16x32_bf16 v[216:219], v[128:131], v[156:159], v[216:219]
    v_mfma_f32_16x16x32_bf16 v[220:223], v[132:135], v[156:159], v[220:223]
    buffer_load_dwordx4 v[152:155], v6, s[44:47], s14 offen sc1
    v_mfma_f32_16x16x32_bf16 v[224:227], v[136:139], v[156:159], v[224:227]
    v_mfma_f32_16x16x32_bf16 v[228:231], v[140:143], v[156:159], v[228:231]
    buffer_load_dwordx4 v[116:119], v2, s[44:47], s13 offen offset:2048 sc1
    v_mfma_f32_16x16x32_bf16 v[232:235], v[144:147], v[156:159], v[232:235]
    v_mfma_f32_16x16x32_bf16 v[236:239], v[128:131], v[160:163], v[236:239]
    v_mfma_f32_16x16x32_bf16 v[240:243], v[132:135], v[160:163], v[240:243]
    buffer_load_dwordx4 v[156:159], v7, s[44:47], s14 offen sc1
    v_mfma_f32_16x16x32_bf16 v[244:247], v[136:139], v[160:163], v[244:247]
    v_mfma_f32_16x16x32_bf16 v[248:251], v[140:143], v[160:163], v[248:251]
    buffer_load_dwordx4 v[120:123], v2, s[44:47], s13 offen offset:3072 sc1
    v_mfma_f32_16x16x32_bf16 v[252:255], v[144:147], v[160:163], v[252:255]
    buffer_load_dwordx4 v[160:163], v8, s[44:47], s14 offen sc1
    s_waitcnt vmcnt(18)
    s_waitcnt lgkmcnt(0)
    s_add_u32 s14, s74, 8192
    v_mfma_f32_16x16x32_bf16 v[176:179], v[48:51], v[40:43], v[176:179]
    ds_read_b128 v[68:71], v13 offset:45056
    v_mfma_f32_16x16x32_bf16 v[180:183], v[52:55], v[40:43], v[180:183]
    ds_read_b128 v[72:75], v13 offset:46080
    v_mfma_f32_16x16x32_bf16 v[184:187], v[56:59], v[40:43], v[184:187]
    ds_read_b128 v[76:79], v13 offset:47104
    v_mfma_f32_16x16x32_bf16 v[188:191], v[60:63], v[40:43], v[188:191]
    ds_read_b128 v[80:83], v13 offset:48128
    v_mfma_f32_16x16x32_bf16 v[192:195], v[64:67], v[40:43], v[192:195]
    ds_read_b128 v[84:87], v13 offset:49152
    v_mfma_f32_16x16x32_bf16 v[196:199], v[48:51], v[44:47], v[196:199]
    v_mfma_f32_16x16x32_bf16 v[200:203], v[52:55], v[44:47], v[200:203]
    buffer_load_dwordx4 v[40:43], v5, s[44:47], s14 offen sc1
    v_mfma_f32_16x16x32_bf16 v[204:207], v[56:59], v[44:47], v[204:207]
    v_mfma_f32_16x16x32_bf16 v[208:211], v[60:63], v[44:47], v[208:211]
    v_mfma_f32_16x16x32_bf16 v[212:215], v[64:67], v[44:47], v[212:215]
    v_mfma_f32_16x16x32_bf16 v[216:219], v[48:51], v[164:167], v[216:219]
    v_mfma_f32_16x16x32_bf16 v[220:223], v[52:55], v[164:167], v[220:223]
    buffer_load_dwordx4 v[44:47], v6, s[44:47], s14 offen sc1
    v_mfma_f32_16x16x32_bf16 v[224:227], v[56:59], v[164:167], v[224:227]
    v_mfma_f32_16x16x32_bf16 v[228:231], v[60:63], v[164:167], v[228:231]
    v_mfma_f32_16x16x32_bf16 v[232:235], v[64:67], v[164:167], v[232:235]
    v_mfma_f32_16x16x32_bf16 v[236:239], v[48:51], v[168:171], v[236:239]
    v_mfma_f32_16x16x32_bf16 v[240:243], v[52:55], v[168:171], v[240:243]
    buffer_load_dwordx4 v[164:167], v7, s[44:47], s14 offen sc1
    v_mfma_f32_16x16x32_bf16 v[244:247], v[56:59], v[168:171], v[244:247]
    v_mfma_f32_16x16x32_bf16 v[248:251], v[60:63], v[168:171], v[248:251]
    v_mfma_f32_16x16x32_bf16 v[252:255], v[64:67], v[168:171], v[252:255]
    buffer_load_dwordx4 v[168:171], v8, s[44:47], s14 offen sc1
    s_waitcnt vmcnt(13)
    s_waitcnt lgkmcnt(0)
    s_add_u32 s14, s75, 0
    v_mfma_f32_16x16x32_bf16 v[176:179], v[68:71], v[24:27], v[176:179]
    ds_read_b128 v[48:51], v175 offset:0
    v_mfma_f32_16x16x32_bf16 v[180:183], v[72:75], v[24:27], v[180:183]
    ds_read_b128 v[52:55], v175 offset:1024
    v_mfma_f32_16x16x32_bf16 v[184:187], v[76:79], v[24:27], v[184:187]
    ds_read_b128 v[56:59], v175 offset:2048
    v_mfma_f32_16x16x32_bf16 v[188:191], v[80:83], v[24:27], v[188:191]
    ds_read_b128 v[60:63], v175 offset:3072
    v_mfma_f32_16x16x32_bf16 v[192:195], v[84:87], v[24:27], v[192:195]
    ds_read_b128 v[64:67], v175 offset:4096
    v_mfma_f32_16x16x32_bf16 v[196:199], v[68:71], v[28:31], v[196:199]
    v_mfma_f32_16x16x32_bf16 v[200:203], v[72:75], v[28:31], v[200:203]
    buffer_load_dwordx4 v[24:27], v5, s[44:47], s14 offen sc1
    v_mfma_f32_16x16x32_bf16 v[204:207], v[76:79], v[28:31], v[204:207]
    v_mfma_f32_16x16x32_bf16 v[208:211], v[80:83], v[28:31], v[208:211]
    v_mfma_f32_16x16x32_bf16 v[212:215], v[84:87], v[28:31], v[212:215]
    v_mfma_f32_16x16x32_bf16 v[216:219], v[68:71], v[32:35], v[216:219]
    v_mfma_f32_16x16x32_bf16 v[220:223], v[72:75], v[32:35], v[220:223]
    buffer_load_dwordx4 v[28:31], v6, s[44:47], s14 offen sc1
    v_mfma_f32_16x16x32_bf16 v[224:227], v[76:79], v[32:35], v[224:227]
    v_mfma_f32_16x16x32_bf16 v[228:231], v[80:83], v[32:35], v[228:231]
    v_mfma_f32_16x16x32_bf16 v[232:235], v[84:87], v[32:35], v[232:235]
    v_mfma_f32_16x16x32_bf16 v[236:239], v[68:71], v[36:39], v[236:239]
    v_mfma_f32_16x16x32_bf16 v[240:243], v[72:75], v[36:39], v[240:243]
    buffer_load_dwordx4 v[32:35], v7, s[44:47], s14 offen sc1
    v_mfma_f32_16x16x32_bf16 v[244:247], v[76:79], v[36:39], v[244:247]
    v_mfma_f32_16x16x32_bf16 v[248:251], v[80:83], v[36:39], v[248:251]
    v_mfma_f32_16x16x32_bf16 v[252:255], v[84:87], v[36:39], v[252:255]
    buffer_load_dwordx4 v[36:39], v8, s[44:47], s14 offen sc1
    s_waitcnt vmcnt(8)
    s_waitcnt lgkmcnt(0)
    s_add_u32 s14, s75, 4096
    v_mfma_f32_16x16x32_bf16 v[176:179], v[48:51], v[148:151], v[176:179]
    ds_read_b128 v[68:71], v175 offset:20480
    v_mfma_f32_16x16x32_bf16 v[180:183], v[52:55], v[148:151], v[180:183]
    ds_read_b128 v[72:75], v175 offset:21504
    v_mfma_f32_16x16x32_bf16 v[184:187], v[56:59], v[148:151], v[184:187]
    ds_read_b128 v[76:79], v175 offset:22528
    v_mfma_f32_16x16x32_bf16 v[188:191], v[60:63], v[148:151], v[188:191]
    ds_read_b128 v[80:83], v175 offset:23552
    v_mfma_f32_16x16x32_bf16 v[192:195], v[64:67], v[148:151], v[192:195]
    ds_read_b128 v[84:87], v175 offset:24576
    v_mfma_f32_16x16x32_bf16 v[196:199], v[48:51], v[152:155], v[196:199]
    v_mfma_f32_16x16x32_bf16 v[200:203], v[52:55], v[152:155], v[200:203]
    buffer_load_dwordx4 v[148:151], v5, s[44:47], s14 offen sc1
    v_mfma_f32_16x16x32_bf16 v[204:207], v[56:59], v[152:155], v[204:207]
    v_mfma_f32_16x16x32_bf16 v[208:211], v[60:63], v[152:155], v[208:211]
    v_mfma_f32_16x16x32_bf16 v[212:215], v[64:67], v[152:155], v[212:215]
    v_mfma_f32_16x16x32_bf16 v[216:219], v[48:51], v[156:159], v[216:219]
    v_mfma_f32_16x16x32_bf16 v[220:223], v[52:55], v[156:159], v[220:223]
    buffer_load_dwordx4 v[152:155], v6, s[44:47], s14 offen sc1
    v_mfma_f32_16x16x32_bf16 v[224:227], v[56:59], v[156:159], v[224:227]
    v_mfma_f32_16x16x32_bf16 v[228:231], v[60:63], v[156:159], v[228:231]
    v_mfma_f32_16x16x32_bf16 v[232:235], v[64:67], v[156:159], v[232:235]
    v_mfma_f32_16x16x32_bf16 v[236:239], v[48:51], v[160:163], v[236:239]
    v_mfma_f32_16x16x32_bf16 v[240:243], v[52:55], v[160:163], v[240:243]
    buffer_load_dwordx4 v[156:159], v7, s[44:47], s14 offen sc1
    v_mfma_f32_16x16x32_bf16 v[244:247], v[56:59], v[160:163], v[244:247]
    v_mfma_f32_16x16x32_bf16 v[248:251], v[60:63], v[160:163], v[248:251]
    v_mfma_f32_16x16x32_bf16 v[252:255], v[64:67], v[160:163], v[252:255]
    buffer_load_dwordx4 v[160:163], v8, s[44:47], s14 offen sc1
    buffer_load_dwordx2 v[172:173], v21, s[44:47], s97 offen sc1
    s_waitcnt vmcnt(9)
    s_waitcnt lgkmcnt(0)
    s_add_u32 s14, s75, 8192
    v_mfma_f32_16x16x32_bf16 v[176:179], v[68:71], v[40:43], v[176:179]
    ds_read_b128 v[48:51], v13 offset:0
    v_mfma_f32_16x16x32_bf16 v[180:183], v[72:75], v[40:43], v[180:183]
    ds_read_b128 v[52:55], v13 offset:1024
    v_mfma_f32_16x16x32_bf16 v[184:187], v[76:79], v[40:43], v[184:187]
    ds_read_b128 v[56:59], v13 offset:2048
    v_mfma_f32_16x16x32_bf16 v[188:191], v[80:83], v[40:43], v[188:191]
    ds_read_b128 v[60:63], v13 offset:3072
    v_mfma_f32_16x16x32_bf16 v[192:195], v[84:87], v[40:43], v[192:195]
    ds_read_b128 v[64:67], v13 offset:4096
    v_mfma_f32_16x16x32_bf16 v[196:199], v[68:71], v[44:47], v[196:199]
    v_mfma_f32_16x16x32_bf16 v[200:203], v[72:75], v[44:47], v[200:203]
    buffer_load_dwordx4 v[40:43], v5, s[44:47], s14 offen sc1
    v_mfma_f32_16x16x32_bf16 v[204:207], v[76:79], v[44:47], v[204:207]
    v_mfma_f32_16x16x32_bf16 v[208:211], v[80:83], v[44:47], v[208:211]
    v_mfma_f32_16x16x32_bf16 v[212:215], v[84:87], v[44:47], v[212:215]
    v_mfma_f32_16x16x32_bf16 v[216:219], v[68:71], v[164:167], v[216:219]
    v_mfma_f32_16x16x32_bf16 v[220:223], v[72:75], v[164:167], v[220:223]
    buffer_load_dwordx4 v[44:47], v6, s[44:47], s14 offen sc1
    v_mfma_f32_16x16x32_bf16 v[224:227], v[76:79], v[164:167], v[224:227]
    v_mfma_f32_16x16x32_bf16 v[228:231], v[80:83], v[164:167], v[228:231]
    v_mfma_f32_16x16x32_bf16 v[232:235], v[84:87], v[164:167], v[232:235]
    v_mfma_f32_16x16x32_bf16 v[236:239], v[68:71], v[168:171], v[236:239]
    v_mfma_f32_16x16x32_bf16 v[240:243], v[72:75], v[168:171], v[240:243]
    buffer_load_dwordx4 v[164:167], v7, s[44:47], s14 offen sc1
    v_mfma_f32_16x16x32_bf16 v[244:247], v[76:79], v[168:171], v[244:247]
    v_mfma_f32_16x16x32_bf16 v[248:251], v[80:83], v[168:171], v[248:251]
    v_mfma_f32_16x16x32_bf16 v[252:255], v[84:87], v[168:171], v[252:255]
    buffer_load_dwordx4 v[168:171], v8, s[44:47], s14 offen sc1
    s_waitcnt vmcnt(9)
    s_waitcnt lgkmcnt(0)
    v_mfma_f32_16x16x32_bf16 v[176:179], v[48:51], v[24:27], v[176:179]
    v_mfma_f32_16x16x32_bf16 v[180:183], v[52:55], v[24:27], v[180:183]
    v_mfma_f32_16x16x32_bf16 v[184:187], v[56:59], v[24:27], v[184:187]
    v_mfma_f32_16x16x32_bf16 v[188:191], v[60:63], v[24:27], v[188:191]
    v_mfma_f32_16x16x32_bf16 v[192:195], v[64:67], v[24:27], v[192:195]
    v_mfma_f32_16x16x32_bf16 v[196:199], v[48:51], v[28:31], v[196:199]
    v_mfma_f32_16x16x32_bf16 v[200:203], v[52:55], v[28:31], v[200:203]
    v_mfma_f32_16x16x32_bf16 v[204:207], v[56:59], v[28:31], v[204:207]
    v_mfma_f32_16x16x32_bf16 v[208:211], v[60:63], v[28:31], v[208:211]
    v_mfma_f32_16x16x32_bf16 v[212:215], v[64:67], v[28:31], v[212:215]
    v_mfma_f32_16x16x32_bf16 v[216:219], v[48:51], v[32:35], v[216:219]
    v_mfma_f32_16x16x32_bf16 v[220:223], v[52:55], v[32:35], v[220:223]
    v_mfma_f32_16x16x32_bf16 v[224:227], v[56:59], v[32:35], v[224:227]
    v_mfma_f32_16x16x32_bf16 v[228:231], v[60:63], v[32:35], v[228:231]
    v_mfma_f32_16x16x32_bf16 v[232:235], v[64:67], v[32:35], v[232:235]
    v_mfma_f32_16x16x32_bf16 v[236:239], v[48:51], v[36:39], v[236:239]
    v_mfma_f32_16x16x32_bf16 v[240:243], v[52:55], v[36:39], v[240:243]
    v_mfma_f32_16x16x32_bf16 v[244:247], v[56:59], v[36:39], v[244:247]
    v_mfma_f32_16x16x32_bf16 v[248:251], v[60:63], v[36:39], v[248:251]
    v_mfma_f32_16x16x32_bf16 v[252:255], v[64:67], v[36:39], v[252:255]
    s_waitcnt vmcnt(4)
    v_xor_b32 v172, s10, v172
    v_xor_b32 v173, s10, v173
    v_or_b32 v172, v172, v173
    v_cmp_ne_u32 vcc, 0, v172
    s_mov_b32 s71, 0
    s_cmp_eq_u64 vcc, 0
    s_cbranch_scc0 L_y1n
    s_mov_b32 s71, 1
    s_add_u32 m0, s92, 24576
    s_nop 0
    buffer_load_dwordx4 v20, s[44:47], s98 offen sc1 lds
    s_add_u32 s98, s98, 131072
    s_add_u32 m0, s92, 25600
    s_nop 0
    buffer_load_dwordx4 v20, s[44:47], s98 offen sc1 lds
    s_add_u32 s98, s98, 131072
    s_add_u32 m0, s92, 26624
    s_mov_b32 exec_hi, 0
    buffer_load_dwordx4 v20, s[44:47], s98 offen sc1 lds
    s_mov_b32 exec_hi, -1
    s_branch L_y1e
L_y1n:
    buffer_load_dwordx2 v[172:173], v21, s[44:47], s97 offen sc1
L_y1e:
    s_waitcnt vmcnt(5)
    s_waitcnt vmcnt(27)
    v_mfma_f32_16x16x32_bf16 v[176:179], v[88:91], v[148:151], v[176:179]
    v_mfma_f32_16x16x32_bf16 v[180:183], v[92:95], v[148:151], v[180:183]
    v_mfma_f32_16x16x32_bf16 v[184:187], v[96:99], v[148:151], v[184:187]
    v_mfma_f32_16x16x32_bf16 v[188:191], v[100:103], v[148:151], v[188:191]
    v_mfma_f32_16x16x32_bf16 v[192:195], v[104:107], v[148:151], v[192:195]
    v_mfma_f32_16x16x32_bf16 v[196:199], v[88:91], v[152:155], v[196:199]
    v_mfma_f32_16x16x32_bf16 v[200:203], v[92:95], v[152:155], v[200:203]
    v_mfma_f32_16x16x32_bf16 v[204:207], v[96:99], v[152:155], v[204:207]
    v_mfma_f32_16x16x32_bf16 v[208:211], v[100:103], v[152:155], v[208:211]
    v_mfma_f32_16x16x32_bf16 v[212:215], v[104:107], v[152:155], v[212:215]
    v_mfma_f32_16x16x32_bf16 v[216:219], v[88:91], v[156:159], v[216:219]
    v_mfma_f32_16x16x32_bf16 v[220:223], v[92:95], v[156:159], v[220:223]
    v_mfma_f32_16x16x32_bf16 v[224:227], v[96:99], v[156:159], v[224:227]
    v_mfma_f32_16x16x32_bf16 v[228:231], v[100:103], v[156:159], v[228:231]
    v_mfma_f32_16x16x32_bf16 v[232:235], v[104:107], v[156:159], v[232:235]
    v_mfma_f32_16x16x32_bf16 v[236:239], v[88:91], v[160:163], v[236:239]
    v_mfma_f32_16x16x32_bf16 v[240:243], v[92:95], v[160:163], v[240:243]
    v_mfma_f32_16x16x32_bf16 v[244:247], v[96:99], v[160:163], v[244:247]
    v_mfma_f32_16x16x32_bf16 v[248:251], v[100:103], v[160:163], v[248:251]
    v_mfma_f32_16x16x32_bf16 v[252:255], v[104:107], v[160:163], v[252:255]
    s_cmp_lg_u32 s71, 0
    s_cbranch_scc1 L_y2e
    s_waitcnt vmcnt(0)
    v_xor_b32 v172, s10, v172
    v_xor_b32 v173, s10, v173
    v_or_b32 v172, v172, v173
    v_cmp_ne_u32 vcc, 0, v172
    s_cmp_eq_u64 vcc, 0
    s_cbranch_scc0 L_y2e
    s_mov_b32 s71, 1
    s_add_u32 m0, s92, 24576
    s_nop 0
    buffer_load_dwordx4 v20, s[44:47], s98 offen sc1 lds
    s_add_u32 s98, s98, 131072
    s_add_u32 m0, s92, 25600
    s_nop 0
    buffer_load_dwordx4 v20, s[44:47], s98 offen sc1 lds
    s_add_u32 s98, s98, 131072
    s_add_u32 m0, s92, 26624
    s_mov_b32 exec_hi, 0
    buffer_load_dwordx4 v20, s[44:47], s98 offen sc1 lds
    s_mov_b32 exec_hi, -1
L_y2e:
    s_waitcnt vmcnt(0)
    s_waitcnt vmcnt(18)
    v_mfma_f32_16x16x32_bf16 v[196:199], v[108:111], v[44:47], v[196:199]
    v_mfma_f32_16x16x32_bf16 v[200:203], v[112:115], v[44:47], v[200:203]
    v_mfma_f32_16x16x32_bf16 v[204:207], v[116:119], v[44:47], v[204:207]
    v_mfma_f32_16x16x32_bf16 v[208:211], v[120:123], v[44:47], v[208:211]
    v_mfma_f32_16x16x32_bf16 v[212:215], v[124:127], v[44:47], v[212:215]
    v_mfma_f32_16x16x32_bf16 v[216:219], v[108:111], v[164:167], v[216:219]
    v_mfma_f32_16x16x32_bf16 v[220:223], v[112:115], v[164:167], v[220:223]
    v_mfma_f32_16x16x32_bf16 v[224:227], v[116:119], v[164:167], v[224:227]
    v_mfma_f32_16x16x32_bf16 v[228:231], v[120:123], v[164:167], v[228:231]
    v_mfma_f32_16x16x32_bf16 v[232:235], v[124:127], v[164:167], v[232:235]
    v_mfma_f32_16x16x32_bf16 v[236:239], v[108:111], v[168:171], v[236:239]
    ds_write_b128 v13, v[196:199] offset:45056
    v_mfma_f32_16x16x32_bf16 v[240:243], v[112:115], v[168:171], v[240:243]
    ds_write_b128 v13, v[200:203] offset:46080
    v_mfma_f32_16x16x32_bf16 v[244:247], v[116:119], v[168:171], v[244:247]
    ds_write_b128 v13, v[204:207] offset:47104
    v_mfma_f32_16x16x32_bf16 v[248:251], v[120:123], v[168:171], v[248:251]
    ds_write_b128 v13, v[208:211] offset:48128
    v_mfma_f32_16x16x32_bf16 v[252:255], v[124:127], v[168:171], v[252:255]
    ds_write_b128 v13, v[212:215] offset:49152
    v_mfma_f32_16x16x32_bf16 v[176:179], v[108:111], v[40:43], v[176:179]
    ds_write_b128 v175, v[216:219] offset:0
    v_mfma_f32_16x16x32_bf16 v[180:183], v[112:115], v[40:43], v[180:183]
    ds_write_b128 v175, v[220:223] offset:1024
    v_mfma_f32_16x16x32_bf16 v[184:187], v[116:119], v[40:43], v[184:187]
    ds_write_b128 v175, v[224:227] offset:2048
    v_mfma_f32_16x16x32_bf16 v[188:191], v[120:123], v[40:43], v[188:191]
    ds_write_b128 v175, v[228:231] offset:3072
    v_mfma_f32_16x16x32_bf16 v[192:195], v[124:127], v[40:43], v[192:195]
    ds_write_b128 v175, v[232:235] offset:4096
    s_cmp_lg_u32 s71, 0
    s_cbranch_scc1 L_y3e
    s_mov_b32 s12, 65536
    s_branch L_spin8_ld
L_spin8:
    s_sleep 14
L_spin8_ld:
    buffer_load_dwordx2 v[172:173], v21, s[44:47], s97 offen sc1
    s_waitcnt vmcnt(0)
L_spin8_chk:
    v_xor_b32 v172, s10, v172
    v_xor_b32 v173, s10, v173
    v_or_b32 v172, v172, v173
    v_cmp_ne_u32 vcc, 0, v172
    s_sub_u32 s12, s12, 1
    s_cselect_b64 vcc, 0, vcc
    s_cmp_eq_u64 vcc, 0
    s_cbranch_scc0 L_spin8
    s_add_u32 m0, s92, 24576
    s_nop 0
    buffer_load_dwordx4 v20, s[44:47], s98 offen sc1 lds
    s_add_u32 s98, s98, 131072
    s_add_u32 m0, s92, 25600
    s_nop 0
    buffer_load_dwordx4 v20, s[44:47], s98 offen sc1 lds
    s_add_u32 s98, s98, 131072
    s_add_u32 m0, s92, 26624
    s_mov_b32 exec_hi, 0
    buffer_load_dwordx4 v20, s[44:47], s98 offen sc1 lds
    s_mov_b32 exec_hi, -1
L_y3e:
    s_mov_b64 s[56:57], s[38:39]
    s_mov_b32 s58, 2621440
    s_mov_b32 s59, 0x20000
    s_nop 4
    ds_write_b128 v175, v[236:239] offset:20480
    ds_write_b128 v175, v[240:243] offset:21504
    ds_write_b128 v175, v[244:247] offset:22528
    ds_write_b128 v175, v[248:251] offset:23552
    ds_write_b128 v175, v[252:255] offset:24576
    s_waitcnt vmcnt(0)
    ds_read_b64_tr_b16 v[24:25], v16 offset:24576
    ds_read_b64_tr_b16 v[26:27], v16 offset:25088
    ds_read_b64_tr_b16 v[28:29], v16 offset:25600
    ds_read_b64_tr_b16 v[30:31], v16 offset:26112
    ds_read_b64_tr_b16 v[32:33], v16 offset:26624
    ds_read_b64 v[34:35], v14 offset:0
    ds_read_b64 v[36:37], v14 offset:32
    ds_read_b64 v[38:39], v14 offset:64
    ds_read_b64 v[40:41], v14 offset:96
    ds_read_b64 v[42:43], v14 offset:128
    v_lshlrev_b32 v172, 16, v23
    v_and_b32 v173, s101, v23
    s_waitcnt lgkmcnt(0)
    s_barrier
    ds_read_b128 v[88:91], v17 offset:0
    ds_read_b128 v[92:95], v18 offset:0
    ds_read_b128 v[96:99], v19 offset:0
    ds_read_b128 v[100:103], v17 offset:1024
    ds_read_b128 v[104:107], v18 offset:1024
    ds_read_b128 v[108:111], v19 offset:1024
    ds_read_b128 v[112:115], v17 offset:2048
    ds_read_b128 v[116:119], v18 offset:2048
    ds_read_b128 v[120:123], v19 offset:2048
    ds_read_b128 v[124:127], v17 offset:3072
    ds_read_b128 v[128:131], v18 offset:3072
    ds_read_b128 v[132:135], v19 offset:3072
    ds_read_b128 v[136:139], v17 offset:4096
    ds_read_b128 v[140:143], v18 offset:4096
    ds_read_b128 v[144:147], v19 offset:4096
    v_lshlrev_b32 v68, 16, v24
    v_and_b32 v69, s101, v24
    v_lshlrev_b32 v70, 16, v34
    v_and_b32 v71, s101, v34
    v_mul_f32 v68, v68, v70
    v_mul_f32 v69, v69, v71
    v_mul_f32 v48, v68, v172
    v_mul_f32 v49, v69, v172
    v_lshlrev_b32 v72, 16, v25
    v_and_b32 v73, s101, v25
    v_lshlrev_b32 v74, 16, v35
    v_and_b32 v75, s101, v35
    v_mul_f32 v72, v72, v74
    v_mul_f32 v73, v73, v75
    v_mul_f32 v50, v72, v172
    v_mul_f32 v51, v73, v172
    v_lshlrev_b32 v76, 16, v26
    v_and_b32 v77, s101, v26
    v_lshlrev_b32 v78, 16, v36
    v_and_b32 v79, s101, v36
    v_mul_f32 v76, v76, v78
    v_mul_f32 v77, v77, v79
    v_mul_f32 v52, v76, v172
    v_mul_f32 v53, v77, v172
    v_lshlrev_b32 v80, 16, v27
    v_and_b32 v81, s101, v27
    v_lshlrev_b32 v82, 16, v37
    v_and_b32 v83, s101, v37
    v_mul_f32 v80, v80, v82
    v_mul_f32 v81, v81, v83
    v_mul_f32 v54, v80, v172
    v_mul_f32 v55, v81, v172
    v_lshlrev_b32 v68, 16, v28
    v_and_b32 v69, s101, v28
    v_lshlrev_b32 v70, 16, v38
    v_and_b32 v71, s101, v38
    v_mul_f32 v68, v68, v70
    v_mul_f32 v69, v69, v71
    v_mul_f32 v56, v68, v172
    v_mul_f32 v57, v69, v172
    v_lshlrev_b32 v72, 16, v29
    v_and_b32 v73, s101, v29
    v_lshlrev_b32 v74, 16, v39
    v_and_b32 v75, s101, v39
    v_mul_f32 v72, v72, v74
    v_mul_f32 v73, v73, v75
    v_mul_f32 v58, v72, v172
    v_mul_f32 v59, v73, v172
    v_lshlrev_b32 v76, 16, v30
    v_and_b32 v77, s101, v30
    v_lshlrev_b32 v78, 16, v40
    v_and_b32 v79, s101, v40
    v_mul_f32 v76, v76, v78
    v_mul_f32 v77, v77, v79
    v_mul_f32 v60, v76, v172
    v_mul_f32 v61, v77, v172
    v_lshlrev_b32 v80, 16, v31
    v_and_b32 v81, s101, v31
    v_lshlrev_b32 v82, 16, v41
    v_and_b32 v83, s101, v41
    v_mul_f32 v80, v80, v82
    v_mul_f32 v81, v81, v83
    v_mul_f32 v62, v80, v172
    v_mul_f32 v63, v81, v172
    v_lshlrev_b32 v68, 16, v32
    v_and_b32 v69, s101, v32
    v_lshlrev_b32 v70, 16, v42
    v_and_b32 v71, s101, v42
    v_mul_f32 v68, v68, v70
    v_mul_f32 v69, v69, v71
    v_mul_f32 v64, v68, v172
    v_mul_f32 v65, v69, v172
    v_lshlrev_b32 v72, 16, v33
    v_and_b32 v73, s101, v33
    v_lshlrev_b32 v74, 16, v43
    v_and_b32 v75, s101, v43
    v_mul_f32 v72, v72, v74
    v_mul_f32 v73, v73, v75
    v_mul_f32 v66, v72, v172
    v_mul_f32 v67, v73, v172
    v_mov_b32 v172, v173
    s_waitcnt lgkmcnt(12)
    v_pk_add_f32 v[176:177], v[176:177], v[88:89]
    v_pk_add_f32 v[178:179], v[178:179], v[90:91]
    v_pk_add_f32 v[176:177], v[176:177], v[92:93]
    v_pk_add_f32 v[178:179], v[178:179], v[94:95]
    v_pk_add_f32 v[176:177], v[176:177], v[96:97]
    v_pk_add_f32 v[178:179], v[178:179], v[98:99]
    v_pk_fma_f32 v[176:177], v[176:177], v[172:173], v[48:49]
    v_pk_fma_f32 v[178:179], v[178:179], v[172:173], v[50:51]
    v_cvt_pk_bf16_f32 v176, v176, v177
    v_cvt_pk_bf16_f32 v177, v178, v179
    ds_write_b64 v15, v[176:177] offset:0
    s_waitcnt lgkmcnt(10)
    v_pk_add_f32 v[180:181], v[180:181], v[100:101]
    v_pk_add_f32 v[182:183], v[182:183], v[102:103]
    v_pk_add_f32 v[180:181], v[180:181], v[104:105]
    v_pk_add_f32 v[182:183], v[182:183], v[106:107]
    v_pk_add_f32 v[180:181], v[180:181], v[108:109]
    v_pk_add_f32 v[182:183], v[182:183], v[110:111]
    v_pk_fma_f32 v[180:181], v[180:181], v[172:173], v[52:53]
    v_pk_fma_f32 v[182:183], v[182:183], v[172:173], v[54:55]
    v_cvt_pk_bf16_f32 v180, v180, v181
    v_cvt_pk_bf16_f32 v181, v182, v183
    ds_write_b64 v15, v[180:181] offset:32
    s_waitcnt lgkmcnt(8)
    v_pk_add_f32 v[184:185], v[184:185], v[112:113]
    v_pk_add_f32 v[186:187], v[186:187], v[114:115]
    v_pk_add_f32 v[184:185], v[184:185], v[116:117]
    v_pk_add_f32 v[186:187], v[186:187], v[118:119]
    v_pk_add_f32 v[184:185], v[184:185], v[120:121]
    v_pk_add_f32 v[186:187], v[186:187], v[122:123]
    v_pk_fma_f32 v[184:185], v[184:185], v[172:173], v[56:57]
    v_pk_fma_f32 v[186:187], v[186:187], v[172:173], v[58:59]
    v_cvt_pk_bf16_f32 v184, v184, v185
    v_cvt_pk_bf16_f32 v185, v186, v187
    ds_write_b64 v15, v[184:185] offset:64
    s_waitcnt lgkmcnt(6)
    v_pk_add_f32 v[188:189], v[188:189], v[124:125]
    v_pk_add_f32 v[190:191], v[190:191], v[126:127]
    v_pk_add_f32 v[188:189], v[188:189], v[128:129]
    v_pk_add_f32 v[190:191], v[190:191], v[130:131]
    v_pk_add_f32 v[188:189], v[188:189], v[132:133]
    v_pk_add_f32 v[190:191], v[190:191], v[134:135]
    v_pk_fma_f32 v[188:189], v[188:189], v[172:173], v[60:61]
    v_pk_fma_f32 v[190:191], v[190:191], v[172:173], v[62:63]
    v_cvt_pk_bf16_f32 v188, v188, v189
    v_cvt_pk_bf16_f32 v189, v190, v191
    ds_write_b64 v15, v[188:189] offset:96
    s_waitcnt lgkmcnt(4)
    v_pk_add_f32 v[192:193], v[192:193], v[136:137]
    v_pk_add_f32 v[194:195], v[194:195], v[138:139]
    v_pk_add_f32 v[192:193], v[192:193], v[140:141]
    v_pk_add_f32 v[194:195], v[194:195], v[142:143]
    v_pk_add_f32 v[192:193], v[192:193], v[144:145]
    v_pk_add_f32 v[194:195], v[194:195], v[146:147]
    v_pk_fma_f32 v[192:193], v[192:193], v[172:173], v[64:65]
    v_pk_fma_f32 v[194:195], v[194:195], v[172:173], v[66:67]
    v_cvt_pk_bf16_f32 v192, v192, v193
    v_cvt_pk_bf16_f32 v193, v194, v195
    ds_write_b64 v15, v[192:193] offset:128
    s_waitcnt lgkmcnt(0)
    ds_read_b128 v[88:91], v13 offset:0
    ds_read_b128 v[92:95], v13 offset:1024
    ds_read_b128 v[96:99], v13 offset:2048
    s_waitcnt lgkmcnt(2)
    buffer_store_dwordx4 v[88:91], v10, s[56:59], s93 offen
    s_waitcnt lgkmcnt(1)
    buffer_store_dwordx4 v[92:95], v11, s[56:59], s93 offen
    s_waitcnt lgkmcnt(0)
    buffer_store_dwordx4 v[96:99], v12, s[56:59], s93 offen
L_end:
    s_endpgm
L_code_end:
.section .rodata,"a"
.p2align 6
.amdhsa_kernel gated_mix__ssm_conv_h3__glu_gated_glu__prompt_kernel
  .amdhsa_next_free_vgpr 256
  .amdhsa_next_free_sgpr 102
  .amdhsa_accum_offset 256
  .amdhsa_group_segment_fixed_size 0
  .amdhsa_kernarg_size 112
  .amdhsa_user_sgpr_count 2
  .amdhsa_user_sgpr_kernarg_segment_ptr 1
  .amdhsa_system_sgpr_workgroup_id_x 1
.end_amdhsa_kernel
```
